```python
import torch

def _softmax(x, axis=-1):
    return torch.softmax(x, dim=axis)
def _gelu(x):
    return torch.nn.functional.gelu(x, approximate="tanh")
def _silu(x):
    return torch.nn.functional.silu(x)
def _sigmoid(x):
    return torch.sigmoid(x)
def _layernorm(x, axis=-1, eps=1e-5):
    m = x.mean(dim=axis, keepdim=True)
    v = x.var(dim=axis, keepdim=True, unbiased=False)
    return (x - m) / torch.sqrt(v + eps)
def _scatter_add(tgt, idx, src, axis=0):
    return tgt.clone().index_add_(axis, idx, src)
def _segment_sum(src, seg, n):
    out = torch.zeros((n,) + src.shape[1:], dtype=src.dtype)
    return out.index_add_(0, seg, src)
def _pad(x, pw):
    flat = tuple(v for pair in reversed(pw) for v in pair)
    return torch.nn.functional.pad(x, flat)

kernel_name = 'sequential_preLN__sliding_block_cached__glu_gated_bilinear__decode'

def setup_inputs():

    _w = (lambda a: (lambda t: t.to(torch.bfloat16) if t.is_floating_point() else t)(torch.as_tensor(a)))
    def _A_setup():
        B, Sq, D = 1, 1, 512
        Hq, Hkv, Sk, Dh = 32, 8, 65536, 128
        assert Hq % Hkv == 0, (Hq, Hkv)
        return {
            "x": _w((lambda *s: torch.randn(*s, dtype=torch.bfloat16) * 0.05)(B, Sq, D)),
            "k_cache": _w((lambda *s: torch.randn(*s, dtype=torch.bfloat16) * 1.6)(B, Hkv, Sk, Dh)),
            "v_cache": _w((lambda *s: torch.randn(*s, dtype=torch.bfloat16) * 0.8)(B, Hkv, Sk, Dh)),
            "wq": _w((lambda *s: torch.randn(*s, dtype=torch.bfloat16) * 1.6)(D, Hq * Dh) * (D ** -0.5)),
            "wo": _w((lambda *s: torch.randn(*s, dtype=torch.bfloat16) * 0.8)(Hq * Dh, D) * ((Hq * Dh) ** -0.5)),
        }
    _A_in = _A_setup()

    def _B_setup():
        B, S, D, F = 1, 1, 512, 1792
        return {
            "x": _w((lambda *s: torch.randn(*s, dtype=torch.bfloat16) * 0.05)(B, S, D)),
            "w_gate": _w((lambda *s: torch.randn(*s, dtype=torch.bfloat16) * 0.4)(D, F) * (D ** -0.5)),
            "w_up": _w((lambda *s: torch.randn(*s, dtype=torch.bfloat16) * 0.4)(D, F) * (D ** -0.5)),
            "w_down": _w((lambda *s: torch.randn(*s, dtype=torch.bfloat16) * 0.4)(F, D) * (F ** -0.5)),
        }
    _B_in = _B_setup()

    return {
        "A_x": _A_in["x"],
        "A_k_cache": _A_in["k_cache"],
        "A_v_cache": _A_in["v_cache"],
        "A_wq": _A_in["wq"],
        "A_wo": _A_in["wo"],
        "B_x": _B_in["x"],
        "B_w_gate": _B_in["w_gate"],
        "B_w_up": _B_in["w_up"],
        "B_w_down": _B_in["w_down"],
    }

def reference(A_x, A_k_cache, A_v_cache, A_wq, A_wo, B_x, B_w_gate, B_w_up, B_w_down):
    def _A_ref(x, k_cache, v_cache, wq, wo):
        B, Sq, D = x.shape
        Hq, Dh = 32, 128
        Hkv, Sk = k_cache.shape[1], k_cache.shape[2]
        W = min(4096, max(256, Sk // 4))
        rep = Hq // Hkv
        q = (lambda x, *d: x.permute(*d))((x @ wq).reshape(B, Sq, Hq, Dh), 0, 2, 1, 3)
        k = (lambda x, n, axis: torch.repeat_interleave(x, n, dim=axis))(k_cache[:, :, Sk - W:, :], rep, axis=1)
        v = (lambda x, n, axis: torch.repeat_interleave(x, n, dim=axis))(v_cache[:, :, Sk - W:, :], rep, axis=1)
        scores = torch.einsum("bhqd,bhkd->bhqk", q, k) * (Dh ** -0.5)
        p = _softmax(scores, axis=-1)
        o = torch.einsum("bhqk,bhkd->bhqd", p, v)
        return (lambda x, *d: x.permute(*d))(o, 0, 2, 1, 3).reshape(B, Sq, Hq * Dh) @ wo

    def _B_ref(x, w_gate, w_up, w_down):
        g = torch.einsum("bsd,df->bsf", x, w_gate)
        u = torch.einsum("bsd,df->bsf", x, w_up)
        h = g * u
        return torch.einsum("bsf,fd->bsd", h, w_down)

    x = A_x
    h = x + _A_ref(_layernorm(x, axis=-1), A_k_cache, A_v_cache, A_wq, A_wo)
    h2 = h + _B_ref(_layernorm(h, axis=-1), B_w_gate, B_w_up, B_w_down)
    return h2
```

```asm
; @launch grid=(256,1,1) block=(512,1,1) lds=125568
.amdgcn_target "amdgcn-amd-amdhsa--gfx950"
.text
.globl sequential_preLN__sliding_block_cached__glu_gated_bilinear__decode_kernel
.p2align 8
.type sequential_preLN__sliding_block_cached__glu_gated_bilinear__decode_kernel,@function
sequential_preLN__sliding_block_cached__glu_gated_bilinear__decode_kernel:
    s_cmp_ge_u32 s2, 0x100
    s_cbranch_scc1 L_END
    s_load_dwordx16 s[4:19], s[0:1], 0x0
    s_load_dwordx8 s[20:27], s[0:1], 0x40
    v_lshrrev_b32 v24, 6, v0
    v_and_b32 v0, 63, v0
    s_lshr_b32 s31, s2, 3
    v_readfirstlane_b32 s29, v24
    s_and_b32 s30, s2, 7
    v_lshlrev_b32 v68, 4, v0
    v_lshrrev_b32 v11, 3, v0
    v_and_b32 v24, 0x70, v68
    v_lshlrev_b32 v71, 2, v11
    v_lshl_or_b32 v72, v11, 14, v24
    s_and_b32 s32, s31, 24
    s_add_u32 s32, s32, s29
    s_and_b32 s35, s31, 7
    s_lshl3_add_u32 s35, s30, s35
    s_lshl_b32 s33, s32, 10
    s_add_u32 s33, s33, s35
    s_lshl_b32 s33, s33, 7
    s_lshl_b32 s32, s32, 5
    v_add_u32 v73, 0x2000, v72
    v_lshrrev_b32 v13, 4, v0
    v_and_b32 v14, 15, v0
    s_lshl3_add_u32 s35, s31, s29
    s_lshl_b32 s34, s30, 12
    v_xor_b32 v24, v14, v13
    s_add_u32 s34, s34, s35
    v_lshlrev_b32 v24, 4, v24
    s_add_u32 s34, s34, 0xf00
    v_lshl_or_b32 v56, v13, 8, v24
    s_lshl_b32 s34, s34, 12
    s_lshl_b32 s50, s29, 12
    s_mov_b32 m0, s50
    s_waitcnt lgkmcnt(0)
    global_load_dwordx4 v[76:79], v68, s[4:5]
    s_add_u32 s36, s4, s32
    s_addc_u32 s37, s5, 0
    global_load_dword v80, v71, s[36:37]
    s_add_u32 s38, s10, s33
    s_addc_u32 s39, s11, 0
    global_load_dwordx4 v[36:39], v72, s[38:39] nt
    global_load_dwordx4 v[40:43], v73, s[38:39] nt
    s_add_u32 s40, s6, s34
    s_addc_u32 s41, s7, 0
    s_barrier
    global_load_lds_dwordx4 v56, s[40:41] offset:0 nt
    s_add_u32 s42, s8, s34
    s_addc_u32 s43, s9, 0
    v_xor_b32 v57, 0x40, v56
    v_xor_b32 v58, 0x80, v56
    v_xor_b32 v59, 0xc0, v56
    v_and_b32 v12, 7, v0
    s_lshl_b32 s33, s30, 5
    s_add_u32 s33, s33, s31
    s_mul_i32 s33, s33, 2048
    s_lshl_b32 s32, s29, 8
    s_add_u32 s33, s33, s32
    s_add_u32 s33, s33, 0x60000
    s_add_u32 s60, s26, s33
    s_addc_u32 s61, s27, 0
    s_lshl_b32 s32, s31, 3
    s_add_u32 s32, s32, s29
    s_cmp_lg_u32 s29, 0
    s_cbranch_scc1 L_NOE
    s_setprio 3
    s_load_dword s28, s[26:27], 0x0
L_NOE:
    s_getpc_b64 s[52:53]
L_PC:
    s_lshl3_add_u32 s33, s31, s29
    s_cmp_gt_u32 s33, (L_CODE_END-L_PC-4)/128
    s_cbranch_scc1 L_NOPF
    s_lshl_b32 s33, s33, 7
    s_load_dword s51, s[52:53], s33
L_NOPF:
    s_xor_b32 s33, s30, 4
    s_lshl_b32 s33, s33, 19
    s_add_u32 s54, s12, s33
    s_addc_u32 s55, s13, 0
    s_cmp_eq_u32 s32, 143
    s_cselect_b64 s[54:55], s[42:43], s[54:55]
    s_cmp_eq_u32 s32, 151
    s_cselect_b64 s[54:55], s[16:17], s[54:55]
    s_cmp_eq_u32 s32, 159
    s_cselect_b64 s[54:55], s[18:19], s[54:55]
    s_cmp_eq_u32 s32, 167
    s_cselect_b64 s[54:55], s[20:21], s[54:55]
    s_cmp_eq_u32 s32, 175
    s_cselect_b64 s[54:55], s[22:23], s[54:55]
    s_sub_u32 s33, s32, 135
    s_and_b32 s35, s33, 0xffffffc7
    s_cmp_lg_u32 s35, 0
    s_cbranch_scc1 L_NOTOUCH
    s_load_dword s51, s[54:55], 0x0
L_NOTOUCH:
    v_lshlrev_b32 v24, 1, v13
    v_xor_b32 v24, v14, v24
    v_lshlrev_b32 v24, 4, v24
    v_lshl_or_b32 v32, v13, 8, v24
    v_xor_b32 v33, 0x80, v32
    s_add_u32 s50, s50, 0x8000
    v_and_b32 v24, 1, v0
    v_lshlrev_b32 v24, 4, v24
    v_mov_b32 v25, 0xffff
    v_lshlrev_b32 v25, v24, v25
    v_lshrrev_b32 v24, 1, v12
    v_cmp_eq_u32 vcc, 0, v24
    s_nop 1
    v_cndmask_b32 v4, 0, v25, vcc
    v_cmp_eq_u32 vcc, 1, v24
    s_nop 1
    v_cndmask_b32 v5, 0, v25, vcc
    v_cmp_eq_u32 vcc, 2, v24
    s_nop 1
    v_cndmask_b32 v6, 0, v25, vcc
    v_cmp_eq_u32 vcc, 3, v24
    s_nop 1
    v_cndmask_b32 v7, 0, v25, vcc
    v_lshrrev_b32 v24, 5, v0
    s_lshl_b32 s32, s29, 1
    v_add_u32 v24, s32, v24
    v_mul_u32_u24 v24, 272, v24
    v_and_b32 v25, 1, v13
    v_lshl_or_b32 v25, v12, 1, v25
    v_lshl_add_u32 v24, v25, 4, v24
    v_add_u32 v15, 0x1c000, v24
    v_and_b32 v24, 3, v0
    v_lshl_add_u32 v18, v13, 2, v24
    v_lshlrev_b32 v18, 4, v18
    v_bfe_u32 v24, v0, 2, 2
    v_mul_u32_u24 v24, 544, v24
    v_add_u32 v25, v18, v24
    v_add_u32 v17, 0x1c000, v25
    v_add_u32 v16, v17, v24
    s_mov_b32 s14, 0x3db504f3
    s_mov_b32 s15, 0x3fb8aa3b
    s_mov_b32 s44, 0xffffff00
    s_mov_b32 s45, 0xfffffc00
    v_lshlrev_b32 v70, 4, v14
    v_mul_u32_u24 v10, 2048, v13
    v_add_u32 v70, v10, v70
    v_mov_b32 v84, 0x3b003b00
    v_mov_b32 v85, 0x3727c5ac
    s_mul_i32 s32, s30, 8192
    s_add_u32 s32, s32, 0x20000
    s_lshr_b32 s33, s31, 3
    s_mul_i32 s33, s33, 0
    s_add_u32 s34, s33, s32
    s_lshl_b32 s33, s31, 8
    s_add_u32 s33, s33, s34
    s_add_u32 s36, s26, s33
    s_addc_u32 s37, s27, 0
    s_lshl_b32 s33, s29, 8
    s_add_u32 s33, s33, s32
    s_add_u32 s38, s26, s33
    s_addc_u32 s39, s27, 0
    s_waitcnt vmcnt(3)
    v_dot2_f32_bf16 v25, v76, v76, 0
    v_dot2_f32_bf16 v24, v76, v84, 0
    v_dot2_f32_bf16 v25, v77, v77, v25
    v_dot2_f32_bf16 v24, v77, v84, v24
    v_dot2_f32_bf16 v25, v78, v78, v25
    v_dot2_f32_bf16 v24, v78, v84, v24
    v_dot2_f32_bf16 v25, v79, v79, v25
    v_dot2_f32_bf16 v24, v79, v84, v24
    s_nop 2
    v_add_f32_dpp v24, v24, v24 row_ror:1 row_mask:0xf bank_mask:0xf
    v_add_f32_dpp v25, v25, v25 row_ror:1 row_mask:0xf bank_mask:0xf
    s_nop 0
    v_add_f32_dpp v24, v24, v24 row_ror:2 row_mask:0xf bank_mask:0xf
    v_add_f32_dpp v25, v25, v25 row_ror:2 row_mask:0xf bank_mask:0xf
    s_nop 0
    v_add_f32_dpp v24, v24, v24 row_ror:4 row_mask:0xf bank_mask:0xf
    v_add_f32_dpp v25, v25, v25 row_ror:4 row_mask:0xf bank_mask:0xf
    s_nop 0
    v_add_f32_dpp v24, v24, v24 row_ror:8 row_mask:0xf bank_mask:0xf
    v_add_f32_dpp v25, v25, v25 row_ror:8 row_mask:0xf bank_mask:0xf
    s_nop 0
    v_add_f32_dpp v24, v24, v24 row_bcast:15 row_mask:0xa bank_mask:0xf
    v_add_f32_dpp v25, v25, v25 row_bcast:15 row_mask:0xa bank_mask:0xf
    s_nop 0
    v_add_f32_dpp v24, v24, v24 row_bcast:31 row_mask:0xc bank_mask:0xf
    v_add_f32_dpp v25, v25, v25 row_bcast:31 row_mask:0xc bank_mask:0xf
    v_mul_f32 v25, 0x3b000000, v25
    v_fma_f32 v25, -v24, v24, v25
    v_max_f32 v25, 0, v25
    v_cvt_pk_bf16_f32 v24, v25, v24
    v_lshlrev_b32 v28, 16, v80
    v_readlane_b32 s58, v24, 63
    v_and_b32 v29, 0xffff0000, v80
    s_lshl_b32 s59, s58, 16
    s_and_b32 s58, s58, 0xffff0000
    v_add_f32 v24, s59, v85
    v_pk_add_f32 v[28:29], v[28:29], s[58:59] op_sel_hi:[1,0] neg_lo:[0,1] neg_hi:[0,1]
    v_cvt_pk_bf16_f32 v24, v24, v24
    v_and_b32 v24, 0xffff0000, v24
    v_sqrt_f32 v24, v24
    v_cvt_pk_bf16_f32 v29, v28, v29
    v_cvt_pk_bf16_f32 v24, v24, v24
    v_and_b32 v24, 0xffff0000, v24
    v_rcp_f32 v26, v24
    v_lshlrev_b32 v28, 16, v29
    v_and_b32 v29, 0xffff0000, v29
    v_pk_mul_f32 v[30:31], v[28:29], v[26:27] op_sel_hi:[1,0]
    v_pk_fma_f32 v[28:29], v[30:31], v[24:25], v[28:29] op_sel_hi:[1,0,1] neg_lo:[1,0,0] neg_hi:[1,0,0]
    v_pk_fma_f32 v[30:31], v[28:29], v[26:27], v[30:31] op_sel_hi:[1,0,1]
    v_cvt_pk_bf16_f32 v30, v30, v30
    v_cvt_pk_bf16_f32 v31, v31, v31
    v_and_b32 v100, v30, v4
    v_and_b32 v101, v30, v5
    v_and_b32 v102, v30, v6
    v_and_b32 v103, v30, v7
    v_and_b32 v104, v31, v4
    v_and_b32 v105, v31, v5
    v_and_b32 v106, v31, v6
    v_and_b32 v107, v31, v7
    s_waitcnt vmcnt(1)
    v_mfma_f32_16x16x32_bf16 v[20:23], v[100:103], v[36:39], 0
    v_mfma_f32_16x16x32_bf16 v[20:23], v[104:107], v[40:43], v[20:23]
    global_load_lds_dwordx4 v57, s[40:41] offset:1024 nt
    s_cmp_lg_u32 s29, 0
    s_cbranch_scc1 L_NOE2
    s_waitcnt lgkmcnt(0)
    s_add_u32 s48, s28, 1
    s_and_b32 s46, s48, 0xff
    s_and_b32 s47, s48, 0x3ff
    v_mov_b32 v8, s46
    v_mov_b32 v9, s47
    v_mov_b32 v24, 0x1ea40
    v_mov_b32 v25, s28
    ds_write_b32 v24, v25
L_NOE2:
    s_mov_b32 exec_lo, 0xff00ff
    s_mov_b32 exec_hi, 0xff00ff00
    s_nop 2
    ds_write_b128 v15, v[20:23]
    s_mov_b64 exec, -1
    global_load_lds_dwordx4 v58, s[40:41] offset:2048 nt
    s_waitcnt lgkmcnt(0)
    s_barrier
    s_cmp_lg_u32 s29, 0
    s_cbranch_scc1 L_QPUB
    ds_read_b128 v[80:83], v16 offset:0
    ds_read_b128 v[84:87], v16 offset:272
    ds_read_b128 v[88:91], v16 offset:544
    ds_read_b128 v[92:95], v16 offset:816
    s_waitcnt lgkmcnt(2)
    v_pk_add_f32 v[80:81], v[80:81], v[84:85]
    v_pk_add_f32 v[82:83], v[82:83], v[86:87]
    s_waitcnt lgkmcnt(0)
    v_pk_add_f32 v[88:89], v[88:89], v[92:93]
    v_pk_add_f32 v[90:91], v[90:91], v[94:95]
    v_pk_add_f32 v[80:81], v[80:81], v[88:89]
    v_pk_add_f32 v[82:83], v[82:83], v[90:91]
    s_nop 0
    v_add_f32_dpp v80, v80, v80 row_ror:4 row_mask:0xf bank_mask:0xf
    v_add_f32_dpp v81, v81, v81 row_ror:4 row_mask:0xf bank_mask:0xf
    v_add_f32_dpp v82, v82, v82 row_ror:4 row_mask:0xf bank_mask:0xf
    v_add_f32_dpp v83, v83, v83 row_ror:4 row_mask:0xf bank_mask:0xf
    v_add_f32_dpp v80, v80, v80 row_ror:8 row_mask:0xf bank_mask:0xf
    v_add_f32_dpp v81, v81, v81 row_ror:8 row_mask:0xf bank_mask:0xf
    v_add_f32_dpp v82, v82, v82 row_ror:8 row_mask:0xf bank_mask:0xf
    v_add_f32_dpp v83, v83, v83 row_ror:8 row_mask:0xf bank_mask:0xf
    v_add_u32 v80, 0x80, v80
    v_add_u32 v81, 0x80, v81
    v_add_u32 v82, 0x80, v82
    v_add_u32 v83, 0x80, v83
    s_mov_b32 exec_lo, 0xf000f
    s_mov_b32 exec_hi, 0xf000f
    v_and_or_b32 v80, v80, s44, v8
    v_and_or_b32 v81, v81, s44, v8
    v_and_or_b32 v82, v82, s44, v8
    v_and_or_b32 v83, v83, s44, v8
    global_store_dwordx4 v18, v[80:83], s[36:37] sc1
    s_mov_b64 exec, -1
    s_waitcnt vmcnt(3)
    global_load_lds_dwordx4 v59, s[40:41] offset:3072 nt
    s_lshl_b32 s32, s29, 12
    v_xor_b32 v24, v14, v13
    v_lshlrev_b32 v24, 4, v24
    v_lshl_or_b32 v24, v14, 8, v24
    v_add_u32 v52, s32, v24
    v_xor_b32 v53, 0x40, v52
    v_xor_b32 v54, 0x80, v52
    v_xor_b32 v55, 0xc0, v52
    v_and_b32 v24, 3, v0
    v_mul_u32_u24 v25, 272, v24
    v_lshl_add_u32 v26, v13, 4, v25
    v_add_u32 v60, 0x1d100, v26
    v_add_u32 v66, 0x1d7c0, v26
    s_lshr_b32 s32, s29, 1
    s_and_b32 s33, s29, 1
    s_lshl_b32 s34, s32, 6
    s_lshl_b32 s35, s33, 3
    s_add_u32 s34, s34, s35
    v_add_u32 v65, s34, v66
    s_mul_i32 s32, s32, 272
    s_lshl_b32 s33, s33, 7
    s_add_u32 s32, s32, s33
    s_add_u32 s32, s32, 0x1d100
    v_lshl_add_u32 v27, v14, 2, v13
    v_lshl_add_u32 v61, v27, 1, s32
    v_lshlrev_b32 v25, 5, v24
    v_add_u32 v63, 0x1d540, v25
    s_lshl_b32 s32, s29, 2
    v_add_u32 v62, s32, v63
    s_lshl_b32 s32, s29, 4
    s_add_u32 s32, s32, 0x1d5c0
    v_lshlrev_b32 v25, 7, v24
    v_lshl_add_u32 v25, v13, 2, v25
    v_add_u32 v64, s32, v25
    v_lshrrev_b32 v25, 2, v0
    v_lshlrev_b32 v25, 3, v25
    v_lshl_add_u32 v25, v24, 7, v25
    v_add_u32 v69, 0x1d5c0, v25
    v_lshrrev_b32 v25, 2, v14
    v_lshl_add_u32 v25, v13, 2, v25
    v_and_b32 v26, 7, v25
    v_lshlrev_b32 v26, 1, v26
    v_bfe_u32 v27, v0, 1, 1
    s_lshl_b32 s32, s29, 1
    v_add_u32 v27, s32, v27
    v_xor_b32 v26, v26, v27
    v_lshlrev_b32 v26, 4, v26
    v_lshl_or_b32 v25, v25, 8, v26
    v_and_b32 v26, 1, v0
    v_lshl_or_b32 v25, v26, 3, v25
    v_add_u32 v67, 0x8000, v25
    s_lshl_b32 s32, s30, 5
    s_add_u32 s32, s32, s31
    s_lshl_b32 s34, s32, 6
    s_add_u32 s34, s34, 0x11000
    s_add_u32 s62, s26, s34
    s_addc_u32 s63, s27, 0
    s_lshl_b32 s32, s30, 14
    s_and_b32 s33, s31, 7
    s_add_u32 s32, s32, s33
    s_lshr_b32 s33, s31, 3
    s_lshl_b32 s33, s33, 7
    s_add_u32 s32, s32, s33
    s_add_u32 s32, s32, 0x138000
    s_add_u32 s94, s26, s32
    s_addc_u32 s95, s27, 0
    s_waitcnt vmcnt(3)
    s_mov_b32 m0, s50
    s_nop 0
    global_load_lds_dwordx4 v32, s[42:43] offset:0 nt
    s_waitcnt vmcnt(3)
    global_load_lds_dwordx4 v33, s[42:43] offset:1024 nt
    s_branch L_PACED
L_QPUB:
    v_mov_b32 v31, 0x1ea40
    ds_read_b32 v31, v31
    s_waitcnt vmcnt(2)
    global_load_lds_dwordx4 v59, s[40:41] offset:3072 nt
    s_waitcnt lgkmcnt(0)
    v_readfirstlane_b32 s28, v31
    s_nop 0
    s_add_u32 s48, s28, 1
    s_and_b32 s46, s48, 0xff
    s_and_b32 s47, s48, 0x3ff
    v_mov_b32 v8, s46
    v_mov_b32 v9, s47
    s_lshl_b32 s32, s29, 12
    v_xor_b32 v24, v14, v13
    v_lshlrev_b32 v24, 4, v24
    v_lshl_or_b32 v24, v14, 8, v24
    v_add_u32 v52, s32, v24
    v_xor_b32 v53, 0x40, v52
    v_xor_b32 v54, 0x80, v52
    v_xor_b32 v55, 0xc0, v52
    v_and_b32 v24, 3, v0
    v_mul_u32_u24 v25, 272, v24
    v_lshl_add_u32 v26, v13, 4, v25
    v_add_u32 v60, 0x1d100, v26
    v_add_u32 v66, 0x1d7c0, v26
    s_lshr_b32 s32, s29, 1
    s_and_b32 s33, s29, 1
    s_lshl_b32 s34, s32, 6
    s_lshl_b32 s35, s33, 3
    s_add_u32 s34, s34, s35
    v_add_u32 v65, s34, v66
    s_mul_i32 s32, s32, 272
    s_lshl_b32 s33, s33, 7
    s_add_u32 s32, s32, s33
    s_add_u32 s32, s32, 0x1d100
    v_lshl_add_u32 v27, v14, 2, v13
    v_lshl_add_u32 v61, v27, 1, s32
    v_lshlrev_b32 v25, 5, v24
    v_add_u32 v63, 0x1d540, v25
    s_lshl_b32 s32, s29, 2
    v_add_u32 v62, s32, v63
    s_lshl_b32 s32, s29, 4
    s_add_u32 s32, s32, 0x1d5c0
    v_lshlrev_b32 v25, 7, v24
    v_lshl_add_u32 v25, v13, 2, v25
    v_add_u32 v64, s32, v25
    v_lshrrev_b32 v25, 2, v0
    v_lshlrev_b32 v25, 3, v25
    v_lshl_add_u32 v25, v24, 7, v25
    v_add_u32 v69, 0x1d5c0, v25
    v_lshrrev_b32 v25, 2, v14
    v_lshl_add_u32 v25, v13, 2, v25
    v_and_b32 v26, 7, v25
    v_lshlrev_b32 v26, 1, v26
    v_bfe_u32 v27, v0, 1, 1
    s_lshl_b32 s32, s29, 1
    v_add_u32 v27, s32, v27
    v_xor_b32 v26, v26, v27
    v_lshlrev_b32 v26, 4, v26
    v_lshl_or_b32 v25, v25, 8, v26
    v_and_b32 v26, 1, v0
    v_lshl_or_b32 v25, v26, 3, v25
    v_add_u32 v67, 0x8000, v25
    s_lshl_b32 s32, s30, 5
    s_add_u32 s32, s32, s31
    s_lshl_b32 s34, s32, 6
    s_add_u32 s34, s34, 0x11000
    s_add_u32 s62, s26, s34
    s_addc_u32 s63, s27, 0
    s_lshl_b32 s32, s30, 14
    s_and_b32 s33, s31, 7
    s_add_u32 s32, s32, s33
    s_lshr_b32 s33, s31, 3
    s_lshl_b32 s33, s33, 7
    s_add_u32 s32, s32, s33
    s_add_u32 s32, s32, 0x138000
    s_add_u32 s94, s26, s32
    s_addc_u32 s95, s27, 0
    s_waitcnt vmcnt(2)
    s_mov_b32 m0, s50
    s_nop 0
    global_load_lds_dwordx4 v32, s[42:43] offset:0 nt
    s_waitcnt vmcnt(2)
    global_load_lds_dwordx4 v33, s[42:43] offset:1024 nt
L_PACED:
    s_setprio 0
    s_cmp_lt_u32 s31, 16
    s_cbranch_scc1 L_ROLE_WO
    s_cmp_lt_u32 s30, 4
    s_cbranch_scc1 L_ROLE_FFN
    s_cmp_lt_u32 s31, 28
    s_cbranch_scc1 L_ROLE_FFN
    s_waitcnt vmcnt(2)
    global_load_dwordx4 v[72:75], v70, s[38:39] sc1
    global_load_lds_dwordx4 v32, s[42:43] offset:2048 nt
    s_waitcnt vmcnt(3)
    global_load_lds_dwordx4 v33, s[42:43] offset:3072 nt
    ds_read_b128 v[80:83], v52
    ds_read_b128 v[84:87], v53
    ds_read_b128 v[88:91], v54
    ds_read_b128 v[92:95], v55
    s_mov_b32 s49, 0
    s_branch L_CHECK1
L_RETRY1:
    s_add_u32 s49, s49, 1
    s_cmp_ge_u32 s49, 0x40000
    s_cbranch_scc1 L_OK1
    s_mov_b64 exec, vcc
    global_load_dwordx4 v[72:75], v70, s[38:39] sc1
    s_waitcnt vmcnt(0)
L_CHECK1:
    s_waitcnt vmcnt(2)
    v_xor_b32 v72, s46, v72
    v_xor_b32 v73, s46, v73
    v_xor_b32 v74, s46, v74
    v_xor_b32 v75, s46, v75
    v_or3_b32 v24, v72, v73, v74
    v_or_b32 v24, v24, v75
    v_and_b32 v24, 0xff, v24
    v_cmp_ne_u32 vcc, 0, v24
    s_cbranch_vccnz L_RETRY1
L_OK1:
    s_mov_b64 exec, -1
    v_permlane32_swap_b32 v72, v74
    v_permlane32_swap_b32 v73, v75
    v_add_f32 v72, v72, v74
    v_add_f32 v73, v73, v75
    s_nop 1
    v_permlane16_swap_b32 v72, v73
    v_add_f32 v72, v72, v73
    v_cvt_pk_bf16_f32 v72, v72, v72
    ds_write_b16 v61, v72
    s_waitcnt lgkmcnt(0)
    s_barrier
    ds_read_b128 v[96:99], v60 offset:0
    ds_read_b128 v[100:103], v60 offset:64
    ds_read_b128 v[104:107], v60 offset:128
    ds_read_b128 v[108:111], v60 offset:192
    s_waitcnt lgkmcnt(3)
    v_mfma_f32_16x16x32_bf16 v[20:23], v[80:83], v[96:99], 0
    s_waitcnt lgkmcnt(2)
    v_mfma_f32_16x16x32_bf16 v[20:23], v[84:87], v[100:103], v[20:23]
    s_waitcnt lgkmcnt(1)
    v_mfma_f32_16x16x32_bf16 v[20:23], v[88:91], v[104:107], v[20:23]
    s_waitcnt lgkmcnt(0)
    v_mfma_f32_16x16x32_bf16 v[20:23], v[92:95], v[108:111], v[20:23]
    s_nop 7
    v_cvt_pk_bf16_f32 v24, v20, v21
    v_cvt_pk_bf16_f32 v25, v22, v23
    v_lshlrev_b32 v112, 16, v24
    v_and_b32 v113, 0xffff0000, v24
    v_lshlrev_b32 v114, 16, v25
    v_and_b32 v115, 0xffff0000, v25
    v_pk_mul_f32 v[112:113], v[112:113], s[14:15] op_sel_hi:[1,0]
    v_pk_mul_f32 v[114:115], v[114:115], s[14:15] op_sel_hi:[1,0]
    v_cvt_pk_bf16_f32 v24, v112, v113
    v_cvt_pk_bf16_f32 v25, v114, v115
    v_lshlrev_b32 v112, 16, v24
    v_and_b32 v113, 0xffff0000, v24
    v_lshlrev_b32 v114, 16, v25
    v_and_b32 v115, 0xffff0000, v25
    v_max3_f32 v116, v112, v113, v114
    v_max_f32 v116, v116, v115
    v_mov_b32 v24, v116
    s_nop 1
    v_permlane16_swap_b32 v116, v24
    v_max_f32 v116, v116, v24
    v_mov_b32 v24, v116
    s_nop 1
    v_permlane32_swap_b32 v116, v24
    v_max_f32 v116, v116, v24
    s_mov_b32 exec_lo, 0xf
    s_mov_b32 exec_hi, 0x0
    ds_write_b32 v62, v116
    s_mov_b64 exec, -1
    s_waitcnt lgkmcnt(0)
    s_barrier
    ds_read_b128 v[24:27], v63
    ds_read_b128 v[28:31], v63 offset:16
    s_waitcnt lgkmcnt(0)
    v_max3_f32 v24, v24, v25, v26
    v_max3_f32 v28, v28, v29, v30
    v_max3_f32 v24, v24, v27, v31
    v_max_f32 v120, v24, v28
    v_pk_add_f32 v[112:113], v[112:113], v[120:121] op_sel_hi:[1,0] neg_lo:[0,1] neg_hi:[0,1]
    v_pk_add_f32 v[114:115], v[114:115], v[120:121] op_sel_hi:[1,0] neg_lo:[0,1] neg_hi:[0,1]
    v_pk_mul_f32 v[112:113], v[112:113], s[14:15] op_sel:[0,1] op_sel_hi:[1,1]
    v_pk_mul_f32 v[114:115], v[114:115], s[14:15] op_sel:[0,1] op_sel_hi:[1,1]
    v_exp_f32 v112, v112
    v_exp_f32 v113, v113
    v_exp_f32 v114, v114
    v_exp_f32 v115, v115
    v_cvt_pk_bf16_f32 v26, v112, v113
    v_cvt_pk_bf16_f32 v27, v114, v115
    s_mov_b32 exec_lo, 0xf000f
    s_mov_b32 exec_hi, 0xf000f
    ds_write_b64 v65, v[26:27]
    v_pk_add_f32 v[24:25], v[112:113], v[114:115]
    v_add_f32 v24, v24, v25
    ds_write_b32 v64, v24
    s_mov_b64 exec, -1
    s_waitcnt lgkmcnt(0)
    s_barrier
    ds_read_b128 v[96:99], v66 offset:0
    ds_read_b128 v[100:103], v66 offset:64
    ds_read_b128 v[104:107], v66 offset:128
    ds_read_b128 v[108:111], v66 offset:192
    s_cmp_lg_u32 s29, 0
    s_cbranch_scc1 L_NOML2
    ds_read_b64 v[24:25], v69
    s_mov_b32 exec_lo, 0xf
    s_mov_b32 exec_hi, 0x0
    v_lshlrev_b32 v26, 10, v0
    global_store_byte v26, v8, s[94:95] sc1
    s_mov_b64 exec, -1
    v_mov_b32 v121, s48
    v_mov_b32 v123, s48
    s_waitcnt lgkmcnt(0)
    v_add_f32 v122, v24, v25
    s_nop 1
    v_add_f32_dpp v122, v122, v122 row_ror:4 row_mask:0xf bank_mask:0xf
    s_nop 1
    v_add_f32_dpp v122, v122, v122 row_ror:8 row_mask:0xf bank_mask:0xf
    v_mov_b32 v24, v122
    s_nop 1
    v_permlane16_swap_b32 v122, v24
    v_add_f32 v122, v122, v24
    v_mov_b32 v24, v122
    s_nop 1
    v_permlane32_swap_b32 v122, v24
    v_add_f32 v122, v122, v24
    s_mov_b32 exec_lo, 0xf
    s_mov_b32 exec_hi, 0x0
    global_store_dwordx4 v68, v[120:123], s[62:63] sc1
    s_mov_b64 exec, -1
    s_waitcnt vmcnt(2)
    s_branch L_MLD2
L_NOML2:
    s_waitcnt vmcnt(0)
L_MLD2:
    s_barrier
    ds_read_b64_tr_b16 v[80:81], v67 offset:0
    ds_read_b64_tr_b16 v[82:83], v67 offset:4096
    ds_read_b64_tr_b16 v[84:85], v67 offset:8192
    ds_read_b64_tr_b16 v[86:87], v67 offset:12288
    ds_read_b64_tr_b16 v[88:89], v67 offset:16384
    ds_read_b64_tr_b16 v[90:91], v67 offset:20480
    ds_read_b64_tr_b16 v[92:93], v67 offset:24576
    ds_read_b64_tr_b16 v[94:95], v67 offset:28672
    s_waitcnt lgkmcnt(6)
    v_mfma_f32_16x16x32_bf16 v[20:23], v[96:99], v[80:83], 0
    s_waitcnt lgkmcnt(4)
    v_mfma_f32_16x16x32_bf16 v[20:23], v[100:103], v[84:87], v[20:23]
    s_waitcnt lgkmcnt(2)
    v_mfma_f32_16x16x32_bf16 v[20:23], v[104:107], v[88:91], v[20:23]
    s_waitcnt lgkmcnt(0)
    v_mfma_f32_16x16x32_bf16 v[20:23], v[108:111], v[92:95], v[20:23]
    s_mov_b32 exec_lo, 0xffff
    s_mov_b32 exec_hi, 0x0
    s_nop 5
    v_and_or_b32 v20, v20, s45, v9
    v_and_or_b32 v21, v21, s45, v9
    v_and_or_b32 v22, v22, s45, v9
    v_and_or_b32 v23, v23, s45, v9
    global_store_dwordx4 v68, v[20:23], s[60:61] sc1
    s_mov_b64 exec, -1
    s_endpgm
L_ROLE_WO:
    s_waitcnt vmcnt(2)
    global_load_dwordx4 v[72:75], v70, s[38:39] sc1
    global_load_lds_dwordx4 v32, s[42:43] offset:2048 nt
    s_waitcnt vmcnt(3)
    global_load_lds_dwordx4 v33, s[42:43] offset:3072 nt
    s_xor_b32 s30, s30, 4
    s_lshr_b32 s33, s31, 3
    s_lshl_b32 s33, s33, 3
    s_add_u32 s33, s33, s29
    s_lshl_b32 s56, s33, 3
    s_lshl_b32 s32, s30, 9
    s_add_u32 s32, s32, s56
    s_lshl_b32 s32, s32, 10
    s_and_b32 s33, s31, 7
    s_lshl_b32 s33, s33, 7
    s_add_u32 s32, s32, s33
    s_add_u32 s54, s12, s32
    s_addc_u32 s55, s13, 0
    v_lshlrev_b32 v80, 4, v12
    v_lshl_or_b32 v80, v11, 10, v80
    v_add_u32 v81, 0x1fc00, v80
    v_add_u32 v82, 0x3f800, v80
    v_add_u32 v83, 0x5f400, v80
    s_lshl_b32 s57, s29, 12
    s_add_u32 s57, s57, 0x10000
    s_mov_b32 m0, s57
    s_nop 0
    global_load_lds_dwordx4 v80, s[54:55] offset:0 nt
    s_waitcnt vmcnt(4)
    global_load_lds_dwordx4 v81, s[54:55] offset:1024 nt
    ds_read_b128 v[148:151], v52
    ds_read_b128 v[152:155], v53
    ds_read_b128 v[156:159], v54
    ds_read_b128 v[160:163], v55
    s_mov_b32 s49, 0
    s_branch L_CHECK3
L_RETRY3:
    s_add_u32 s49, s49, 1
    s_cmp_ge_u32 s49, 0x40000
    s_cbranch_scc1 L_OK3
    s_mov_b64 exec, vcc
    global_load_dwordx4 v[72:75], v70, s[38:39] sc1
    s_waitcnt vmcnt(0)
L_CHECK3:
    s_waitcnt vmcnt(4)
    v_xor_b32 v72, s46, v72
    v_xor_b32 v73, s46, v73
    v_xor_b32 v74, s46, v74
    v_xor_b32 v75, s46, v75
    v_or3_b32 v24, v72, v73, v74
    v_or_b32 v24, v24, v75
    v_and_b32 v24, 0xff, v24
    v_cmp_ne_u32 vcc, 0, v24
    s_cbranch_vccnz L_RETRY3
L_OK3:
    s_mov_b64 exec, -1
    v_permlane32_swap_b32 v72, v74
    v_permlane32_swap_b32 v73, v75
    v_add_f32 v72, v72, v74
    v_add_f32 v73, v73, v75
    s_nop 1
    v_permlane16_swap_b32 v72, v73
    v_add_f32 v72, v72, v73
    v_cvt_pk_bf16_f32 v72, v72, v72
    ds_write_b16 v61, v72
    s_waitcnt lgkmcnt(0)
    s_barrier
    ds_read_b128 v[164:167], v60 offset:0
    ds_read_b128 v[168:171], v60 offset:64
    ds_read_b128 v[172:175], v60 offset:128
    ds_read_b128 v[176:179], v60 offset:192
    s_waitcnt lgkmcnt(3)
    v_mfma_f32_16x16x32_bf16 v[20:23], v[148:151], v[164:167], 0
    s_waitcnt lgkmcnt(2)
    v_mfma_f32_16x16x32_bf16 v[20:23], v[152:155], v[168:171], v[20:23]
    s_waitcnt lgkmcnt(1)
    v_mfma_f32_16x16x32_bf16 v[20:23], v[156:159], v[172:175], v[20:23]
    s_waitcnt lgkmcnt(0)
    v_mfma_f32_16x16x32_bf16 v[20:23], v[160:163], v[176:179], v[20:23]
    s_nop 7
    v_cvt_pk_bf16_f32 v24, v20, v21
    v_cvt_pk_bf16_f32 v25, v22, v23
    v_lshlrev_b32 v180, 16, v24
    v_and_b32 v181, 0xffff0000, v24
    v_lshlrev_b32 v182, 16, v25
    v_and_b32 v183, 0xffff0000, v25
    v_pk_mul_f32 v[180:181], v[180:181], s[14:15] op_sel_hi:[1,0]
    v_pk_mul_f32 v[182:183], v[182:183], s[14:15] op_sel_hi:[1,0]
    v_cvt_pk_bf16_f32 v24, v180, v181
    v_cvt_pk_bf16_f32 v25, v182, v183
    v_lshlrev_b32 v180, 16, v24
    v_and_b32 v181, 0xffff0000, v24
    v_lshlrev_b32 v182, 16, v25
    v_and_b32 v183, 0xffff0000, v25
    v_max3_f32 v184, v180, v181, v182
    v_max_f32 v184, v184, v183
    v_mov_b32 v24, v184
    s_nop 1
    v_permlane16_swap_b32 v184, v24
    v_max_f32 v184, v184, v24
    v_mov_b32 v24, v184
    s_nop 1
    v_permlane32_swap_b32 v184, v24
    v_max_f32 v184, v184, v24
    s_mov_b32 exec_lo, 0xf
    s_mov_b32 exec_hi, 0x0
    ds_write_b32 v62, v184
    s_mov_b64 exec, -1
    global_load_lds_dwordx4 v82, s[54:55] offset:2048 nt
    global_load_lds_dwordx4 v83, s[54:55] offset:3072 nt
    s_waitcnt lgkmcnt(0)
    s_barrier
    ds_read_b128 v[24:27], v63
    ds_read_b128 v[28:31], v63 offset:16
    s_waitcnt lgkmcnt(0)
    v_max3_f32 v24, v24, v25, v26
    v_max3_f32 v28, v28, v29, v30
    v_max3_f32 v24, v24, v27, v31
    v_max_f32 v188, v24, v28
    v_pk_add_f32 v[180:181], v[180:181], v[188:189] op_sel_hi:[1,0] neg_lo:[0,1] neg_hi:[0,1]
    v_pk_add_f32 v[182:183], v[182:183], v[188:189] op_sel_hi:[1,0] neg_lo:[0,1] neg_hi:[0,1]
    v_pk_mul_f32 v[180:181], v[180:181], s[14:15] op_sel:[0,1] op_sel_hi:[1,1]
    v_pk_mul_f32 v[182:183], v[182:183], s[14:15] op_sel:[0,1] op_sel_hi:[1,1]
    v_exp_f32 v180, v180
    v_exp_f32 v181, v181
    v_exp_f32 v182, v182
    v_exp_f32 v183, v183
    v_cvt_pk_bf16_f32 v26, v180, v181
    v_cvt_pk_bf16_f32 v27, v182, v183
    s_mov_b32 exec_lo, 0xf000f
    s_mov_b32 exec_hi, 0xf000f
    ds_write_b64 v65, v[26:27]
    v_pk_add_f32 v[24:25], v[180:181], v[182:183]
    v_add_f32 v24, v24, v25
    ds_write_b32 v64, v24
    s_mov_b64 exec, -1
    s_waitcnt lgkmcnt(0)
    s_barrier
    ds_read_b128 v[164:167], v66 offset:0
    ds_read_b128 v[168:171], v66 offset:64
    ds_read_b128 v[172:175], v66 offset:128
    ds_read_b128 v[176:179], v66 offset:192
    s_cmp_lg_u32 s29, 0
    s_cbranch_scc1 L_NOML4
    ds_read_b64 v[24:25], v69
    s_mov_b32 exec_lo, 0xf
    s_mov_b32 exec_hi, 0x0
    v_lshlrev_b32 v26, 10, v0
    global_store_byte v26, v8, s[94:95] sc1
    s_mov_b64 exec, -1
    v_mov_b32 v189, s48
    v_mov_b32 v191, s48
    s_waitcnt lgkmcnt(0)
    v_add_f32 v190, v24, v25
    s_nop 1
    v_add_f32_dpp v190, v190, v190 row_ror:4 row_mask:0xf bank_mask:0xf
    s_nop 1
    v_add_f32_dpp v190, v190, v190 row_ror:8 row_mask:0xf bank_mask:0xf
    v_mov_b32 v24, v190
    s_nop 1
    v_permlane16_swap_b32 v190, v24
    v_add_f32 v190, v190, v24
    v_mov_b32 v24, v190
    s_nop 1
    v_permlane32_swap_b32 v190, v24
    v_add_f32 v190, v190, v24
    s_mov_b32 exec_lo, 0xf
    s_mov_b32 exec_hi, 0x0
    global_store_dwordx4 v68, v[188:191], s[62:63] sc1
    s_mov_b64 exec, -1
    s_waitcnt vmcnt(6)
    s_branch L_MLD4
L_NOML4:
    s_waitcnt vmcnt(4)
L_MLD4:
    s_barrier
    ds_read_b64_tr_b16 v[148:149], v67 offset:0
    ds_read_b64_tr_b16 v[150:151], v67 offset:4096
    ds_read_b64_tr_b16 v[152:153], v67 offset:8192
    ds_read_b64_tr_b16 v[154:155], v67 offset:12288
    ds_read_b64_tr_b16 v[156:157], v67 offset:16384
    ds_read_b64_tr_b16 v[158:159], v67 offset:20480
    ds_read_b64_tr_b16 v[160:161], v67 offset:24576
    ds_read_b64_tr_b16 v[162:163], v67 offset:28672
    s_waitcnt lgkmcnt(6)
    v_mfma_f32_16x16x32_bf16 v[20:23], v[164:167], v[148:151], 0
    s_waitcnt lgkmcnt(4)
    v_mfma_f32_16x16x32_bf16 v[20:23], v[168:171], v[152:155], v[20:23]
    s_waitcnt lgkmcnt(2)
    v_mfma_f32_16x16x32_bf16 v[20:23], v[172:175], v[156:159], v[20:23]
    s_waitcnt lgkmcnt(0)
    v_mfma_f32_16x16x32_bf16 v[20:23], v[176:179], v[160:163], v[20:23]
    s_mov_b32 exec_lo, 0xffff
    s_mov_b32 exec_hi, 0x0
    s_nop 5
    v_and_or_b32 v20, v20, s45, v9
    v_and_or_b32 v21, v21, s45, v9
    v_and_or_b32 v22, v22, s45, v9
    v_and_or_b32 v23, v23, s45, v9
    global_store_dwordx4 v68, v[20:23], s[60:61] sc1
    s_mov_b64 exec, -1
    s_cmp_lg_u32 s29, 0
    s_cbranch_scc1 L_BP
    s_mul_i32 s92, s46, 0x01010101
    s_mov_b32 s93, s92
    s_and_b32 s32, s31, 3
    s_lshl4_add_u32 s32, s30, s32
    s_lshl_b32 s32, s32, 10
    s_add_u32 s32, s32, 0x138000
    s_add_u32 s38, s26, s32
    s_addc_u32 s39, s27, 0
    s_load_dwordx2 s[4:5], s[38:39], 0x0 glc
    s_load_dwordx2 s[6:7], s[38:39], 0x80 glc
    s_load_dwordx2 s[8:9], s[38:39], 0x100 glc
    s_load_dwordx2 s[10:11], s[38:39], 0x180 glc
L_BP:
    s_lshl_b32 s33, s30, 11
    s_add_u32 s33, s33, 0x11000
    s_add_u32 s36, s26, s33
    s_addc_u32 s37, s27, 0
    s_mul_i32 s33, s30, 65536
    s_lshl_b32 s32, s56, 4
    s_add_u32 s33, s33, s32
    s_add_u32 s33, s33, 0x60000
    s_add_u32 s98, s26, s33
    s_addc_u32 s99, s27, 0
    v_lshlrev_b32 v24, 4, v12
    v_mul_u32_u24 v84, 2048, v11
    v_add_u32 v84, v84, v24
    v_add_u32 v85, 0x4000, v84
    v_add_u32 v86, 0x8000, v84
    v_add_u32 v87, 0xc000, v84
    s_lshr_b32 s33, s31, 3
    s_lshl1_add_u32 s32, s30, s33
    s_mul_i32 s32, s32, 2048
    s_and_b32 s33, s31, 7
    s_lshl_b32 s33, s33, 8
    s_add_u32 s32, s32, s33
    s_add_u32 s32, s32, 0x40000
    s_add_u32 s40, s26, s32
    s_addc_u32 s41, s27, 0
    v_lshrrev_b32 v24, 2, v14
    v_lshl_add_u32 v24, v13, 3, v24
    v_lshlrev_b32 v24, 7, v24
    v_and_b32 v25, 3, v0
    v_lshl_add_u32 v24, v25, 3, v24
    v_add_u32 v88, s57, v24
    v_lshlrev_b32 v24, 4, v11
    v_add_u32 v89, 0x1e840, v24
    s_mul_i32 s32, s29, 272
    s_add_u32 s32, s32, 0x1c000
    v_lshl_add_u32 v90, v13, 4, s32
    s_and_b32 s32, s30, 7
    s_lshl_b32 s32, s32, 2
    s_lshr_b32 s33, s30, 3
    s_lshl_b32 s33, s33, 7
    s_add_u32 s32, s32, s33
    s_add_u32 s100, s32, 0x160000
    s_cmp_eq_u32 s29, 0
    s_cbranch_scc1 L_BELL1
    s_barrier
    global_load_dwordx4 v[92:95], v84, s[98:99] sc1
    global_load_dwordx4 v[96:99], v85, s[98:99] sc1
    global_load_dwordx4 v[100:103], v86, s[98:99] sc1
    global_load_dwordx4 v[104:107], v87, s[98:99] sc1
    s_waitcnt vmcnt(4)
    ds_read_b64_tr_b16 v[36:37], v88 offset:0
    ds_read_b64_tr_b16 v[38:39], v88 offset:512
    ds_read_b64_tr_b16 v[40:41], v88 offset:32
    ds_read_b64_tr_b16 v[42:43], v88 offset:544
    ds_read_b64_tr_b16 v[44:45], v88 offset:64
    ds_read_b64_tr_b16 v[46:47], v88 offset:576
    ds_read_b64_tr_b16 v[48:49], v88 offset:96
    ds_read_b64_tr_b16 v[50:51], v88 offset:608
    s_branch L_BELL2
L_BELL1:
    s_waitcnt lgkmcnt(0)
    s_cmp_eq_u64 s[4:5], s[92:93]
    s_cbranch_scc0 L_VEC
    s_cmp_eq_u64 s[6:7], s[92:93]
    s_cbranch_scc0 L_VEC
    s_cmp_eq_u64 s[8:9], s[92:93]
    s_cbranch_scc0 L_VEC
    s_cmp_eq_u64 s[10:11], s[92:93]
    s_cbranch_scc0 L_VEC
    s_barrier
    global_load_dwordx4 v[124:127], v68, s[36:37] offset:0 sc1
    global_load_dwordx4 v[128:131], v68, s[36:37] offset:1024 sc1
    global_load_dwordx4 v[92:95], v84, s[98:99] sc1
    global_load_dwordx4 v[96:99], v85, s[98:99] sc1
    global_load_dwordx4 v[100:103], v86, s[98:99] sc1
    global_load_dwordx4 v[104:107], v87, s[98:99] sc1
    s_mov_b32 s49, 0
    s_branch L_CHECK5
L_RETRY5:
    s_add_u32 s49, s49, 1
    s_cmp_ge_u32 s49, 0x40000
    s_cbranch_scc1 L_OK5
    s_mov_b64 exec, vcc
    global_load_dwordx4 v[124:127], v68, s[36:37] offset:0 sc1
    global_load_dwordx4 v[128:131], v68, s[36:37] offset:1024 sc1
    s_waitcnt vmcnt(0)
L_CHECK5:
    s_waitcnt vmcnt(4)
    v_xor_b32 v24, s48, v125
    v_bitop3_b32 v24, v24, v127, s48 bitop3:0xf6
    v_bitop3_b32 v24, v24, v129, s48 bitop3:0xf6
    v_bitop3_b32 v24, v24, v131, s48 bitop3:0xf6
    v_cmp_ne_u32 vcc, 0, v24
    s_cbranch_vccnz L_RETRY5
L_OK5:
    s_mov_b64 exec, -1
    s_branch L_WTS
L_VEC:
    global_load_dwordx4 v[124:127], v68, s[36:37] offset:0 sc1
    global_load_dwordx4 v[128:131], v68, s[36:37] offset:1024 sc1
    s_mov_b32 s49, 0
    s_branch L_CHECK6
L_RETRY6:
    s_add_u32 s49, s49, 1
    s_cmp_ge_u32 s49, 0x40000
    s_cbranch_scc1 L_OK6
    s_mov_b64 exec, vcc
    global_load_dwordx4 v[124:127], v68, s[36:37] offset:0 sc1
    global_load_dwordx4 v[128:131], v68, s[36:37] offset:1024 sc1
L_CHECK6:
    s_waitcnt vmcnt(0)
    v_xor_b32 v24, s48, v125
    v_bitop3_b32 v24, v24, v127, s48 bitop3:0xf6
    v_bitop3_b32 v24, v24, v129, s48 bitop3:0xf6
    v_bitop3_b32 v24, v24, v131, s48 bitop3:0xf6
    v_cmp_ne_u32 vcc, 0, v24
    s_cbranch_vccnz L_RETRY6
L_OK6:
    s_mov_b64 exec, -1
    s_barrier
    global_load_dwordx4 v[92:95], v84, s[98:99] sc1
    global_load_dwordx4 v[96:99], v85, s[98:99] sc1
    global_load_dwordx4 v[100:103], v86, s[98:99] sc1
    global_load_dwordx4 v[104:107], v87, s[98:99] sc1
L_WTS:
    v_max_f32 v25, v124, v128
    s_nop 1
    v_max_f32_dpp v25, v25, v25 row_ror:4 row_mask:0xf bank_mask:0xf
    s_nop 1
    v_max_f32_dpp v25, v25, v25 row_ror:8 row_mask:0xf bank_mask:0xf
    v_mov_b32 v24, v25
    s_nop 1
    v_permlane16_swap_b32 v25, v24
    v_max_f32 v25, v25, v24
    v_mov_b32 v24, v25
    s_nop 1
    v_permlane32_swap_b32 v25, v24
    v_max_f32 v25, v25, v24
    v_sub_f32 v124, v124, v25
    v_sub_f32 v128, v128, v25
    v_mul_f32 v124, 0x3fb8aa3b, v124
    v_mul_f32 v128, 0x3fb8aa3b, v128
    v_exp_f32 v124, v124
    v_exp_f32 v128, v128
    v_lshlrev_b32 v26, 2, v0
    v_mul_f32 v25, v124, v126
    v_fmac_f32 v25, v128, v130
    s_nop 1
    v_add_f32_dpp v25, v25, v25 row_ror:4 row_mask:0xf bank_mask:0xf
    s_nop 1
    v_add_f32_dpp v25, v25, v25 row_ror:8 row_mask:0xf bank_mask:0xf
    v_mov_b32 v24, v25
    s_nop 1
    v_permlane16_swap_b32 v25, v24
    v_add_f32 v25, v25, v24
    v_mov_b32 v24, v25
    s_nop 1
    v_permlane32_swap_b32 v25, v24
    v_add_f32 v25, v25, v24
    v_rcp_f32 v25, v25
    v_add_u32 v26, 0x1e840, v26
    v_mul_f32 v124, v124, v25
    v_mul_f32 v128, v128, v25
    ds_write_b32 v26, v124 offset:0
    ds_write_b32 v26, v128 offset:256
    s_waitcnt lgkmcnt(0)
    s_barrier
    ds_read_b64_tr_b16 v[36:37], v88 offset:0
    ds_read_b64_tr_b16 v[38:39], v88 offset:512
    ds_read_b64_tr_b16 v[40:41], v88 offset:32
    ds_read_b64_tr_b16 v[42:43], v88 offset:544
    ds_read_b64_tr_b16 v[44:45], v88 offset:64
    ds_read_b64_tr_b16 v[46:47], v88 offset:576
    ds_read_b64_tr_b16 v[48:49], v88 offset:96
    ds_read_b64_tr_b16 v[50:51], v88 offset:608
    s_branch L_BELL3
L_BELL2:
    s_barrier
L_BELL3:
    ds_read_b128 v[108:111], v89 offset:0
    ds_read_b128 v[112:115], v89 offset:128
    ds_read_b128 v[116:119], v89 offset:256
    ds_read_b128 v[120:123], v89 offset:384
    s_mov_b32 s49, 0
    s_branch L_FIRST7
L_RETRY7:
    s_add_u32 s49, s49, 1
    s_cmp_ge_u32 s49, 0x40000
    s_cbranch_scc1 L_REDO7
    s_mov_b64 exec, vcc
    global_load_dwordx4 v[92:95], v84, s[98:99] sc1
    global_load_dwordx4 v[96:99], v85, s[98:99] sc1
    global_load_dwordx4 v[100:103], v86, s[98:99] sc1
    global_load_dwordx4 v[104:107], v87, s[98:99] sc1
    s_waitcnt vmcnt(0)
    v_xor_b32 v92, s47, v92
    v_xor_b32 v93, s47, v93
    v_xor_b32 v94, s47, v94
    v_xor_b32 v95, s47, v95
    v_or3_b32 v10, v92, v93, v94
    v_or_b32 v10, v10, v95
    v_xor_b32 v96, s47, v96
    v_xor_b32 v97, s47, v97
    v_xor_b32 v98, s47, v98
    v_xor_b32 v99, s47, v99
    v_or3_b32 v10, v10, v96, v97
    v_or3_b32 v10, v10, v98, v99
    v_xor_b32 v100, s47, v100
    v_xor_b32 v101, s47, v101
    v_xor_b32 v102, s47, v102
    v_xor_b32 v103, s47, v103
    v_or3_b32 v10, v10, v100, v101
    v_or3_b32 v10, v10, v102, v103
    v_xor_b32 v104, s47, v104
    v_xor_b32 v105, s47, v105
    v_xor_b32 v106, s47, v106
    v_xor_b32 v107, s47, v107
    v_or3_b32 v10, v10, v104, v105
    v_or3_b32 v10, v10, v106, v107
    v_and_b32 v10, 0x3ff, v10
    v_cmp_ne_u32 vcc, 0, v10
    s_cbranch_vccnz L_RETRY7
L_REDO7:
    s_mov_b64 exec, -1
    v_pk_mul_f32 v[24:25], v[92:93], v[108:109]
    v_pk_mul_f32 v[26:27], v[94:95], v[110:111]
    v_pk_fma_f32 v[24:25], v[96:97], v[112:113], v[24:25]
    v_pk_fma_f32 v[26:27], v[98:99], v[114:115], v[26:27]
    v_pk_fma_f32 v[24:25], v[100:101], v[116:117], v[24:25]
    v_pk_fma_f32 v[26:27], v[102:103], v[118:119], v[26:27]
    v_pk_fma_f32 v[24:25], v[104:105], v[120:121], v[24:25]
    v_pk_fma_f32 v[26:27], v[106:107], v[122:123], v[26:27]
    s_branch L_OK7
L_FIRST7:
    s_waitcnt lgkmcnt(0)
    s_waitcnt vmcnt(3)
    v_xor_b32 v92, s47, v92
    v_xor_b32 v93, s47, v93
    v_xor_b32 v94, s47, v94
    v_xor_b32 v95, s47, v95
    v_or3_b32 v10, v92, v93, v94
    v_or_b32 v10, v10, v95
    v_pk_mul_f32 v[24:25], v[92:93], v[108:109]
    v_pk_mul_f32 v[26:27], v[94:95], v[110:111]
    s_waitcnt vmcnt(2)
    v_xor_b32 v96, s47, v96
    v_xor_b32 v97, s47, v97
    v_xor_b32 v98, s47, v98
    v_xor_b32 v99, s47, v99
    v_or3_b32 v10, v10, v96, v97
    v_or3_b32 v10, v10, v98, v99
    v_pk_fma_f32 v[24:25], v[96:97], v[112:113], v[24:25]
    v_pk_fma_f32 v[26:27], v[98:99], v[114:115], v[26:27]
    s_waitcnt vmcnt(1)
    v_xor_b32 v100, s47, v100
    v_xor_b32 v101, s47, v101
    v_xor_b32 v102, s47, v102
    v_xor_b32 v103, s47, v103
    v_or3_b32 v10, v10, v100, v101
    v_or3_b32 v10, v10, v102, v103
    v_pk_fma_f32 v[24:25], v[100:101], v[116:117], v[24:25]
    v_pk_fma_f32 v[26:27], v[102:103], v[118:119], v[26:27]
    s_waitcnt vmcnt(0)
    v_xor_b32 v104, s47, v104
    v_xor_b32 v105, s47, v105
    v_xor_b32 v106, s47, v106
    v_xor_b32 v107, s47, v107
    v_or3_b32 v10, v10, v104, v105
    v_or3_b32 v10, v10, v106, v107
    v_and_b32 v10, 0x3ff, v10
    v_cmp_ne_u32 vcc, 0, v10
    v_pk_fma_f32 v[24:25], v[104:105], v[120:121], v[24:25]
    v_pk_fma_f32 v[26:27], v[106:107], v[122:123], v[26:27]
    s_cbranch_vccnz L_RETRY7
L_OK7:
    s_nop 0
    v_permlane32_swap_b32 v24, v26
    v_permlane32_swap_b32 v25, v27
    v_add_f32 v24, v24, v26
    v_add_f32 v25, v25, v27
    s_nop 1
    v_permlane16_swap_b32 v24, v25
    v_add_f32 v24, v24, v25
    s_nop 1
    v_add_f32_dpp v24, v24, v24 row_ror:8 row_mask:0xf bank_mask:0xf
    s_nop 1
    v_mov_b32_dpp v25, v24 quad_perm:[1,1,3,3] row_mask:0xf bank_mask:0xf
    v_cvt_pk_bf16_f32 v25, v24, v25
    s_nop 1
    v_mov_b32_dpp v28, v25 row_newbcast:0 row_mask:0xf bank_mask:0xf
    v_mov_b32_dpp v29, v25 row_newbcast:2 row_mask:0xf bank_mask:0xf
    v_mov_b32_dpp v30, v25 row_newbcast:4 row_mask:0xf bank_mask:0xf
    v_mov_b32_dpp v31, v25 row_newbcast:6 row_mask:0xf bank_mask:0xf
    s_nop 1
    v_mfma_f32_16x16x32_bf16 v[132:135], v[36:39], v[28:31], 0
    v_mfma_f32_16x16x32_bf16 v[136:139], v[40:43], v[28:31], 0
    v_mfma_f32_16x16x32_bf16 v[140:143], v[44:47], v[28:31], 0
    v_mfma_f32_16x16x32_bf16 v[144:147], v[48:51], v[28:31], 0
    s_or_b32 s32, s31, s29
    s_cbranch_scc1 L_NOHINT
    s_mov_b32 exec_lo, 0xffff
    s_mov_b32 exec_hi, 0x0
    v_lshl_add_u32 v10, v0, 7, s100
    v_mov_b32 v70, s48
    global_store_dword v10, v70, s[26:27] sc1
    s_mov_b64 exec, -1
L_NOHINT:
    s_mov_b32 exec_lo, 0x10001
    s_mov_b32 exec_hi, 0x10001
    s_nop 0
    ds_write_b128 v90, v[132:135] offset:0
    ds_write_b128 v90, v[136:139] offset:64
    ds_write_b128 v90, v[140:143] offset:128
    ds_write_b128 v90, v[144:147] offset:192
    s_mov_b64 exec, -1
    s_waitcnt lgkmcnt(0)
    s_barrier
    s_cmp_lg_u32 s29, 0
    s_cbranch_scc1 L_FIN
    ds_read_b128 v[148:151], v17 offset:0
    ds_read_b128 v[152:155], v17 offset:272
    s_waitcnt lgkmcnt(0)
    v_pk_add_f32 v[148:149], v[148:149], v[152:153]
    v_pk_add_f32 v[150:151], v[150:151], v[154:155]
    s_nop 0
    v_add_f32_dpp v148, v148, v148 row_ror:4 row_mask:0xf bank_mask:0xf
    v_add_f32_dpp v149, v149, v149 row_ror:4 row_mask:0xf bank_mask:0xf
    v_add_f32_dpp v150, v150, v150 row_ror:4 row_mask:0xf bank_mask:0xf
    v_add_f32_dpp v151, v151, v151 row_ror:4 row_mask:0xf bank_mask:0xf
    v_add_f32_dpp v148, v148, v148 row_ror:8 row_mask:0xf bank_mask:0xf
    v_add_f32_dpp v149, v149, v149 row_ror:8 row_mask:0xf bank_mask:0xf
    v_add_f32_dpp v150, v150, v150 row_ror:8 row_mask:0xf bank_mask:0xf
    v_add_f32_dpp v151, v151, v151 row_ror:8 row_mask:0xf bank_mask:0xf
    s_mov_b32 exec_lo, 0xf000f
    s_mov_b32 exec_hi, 0xf000f
    v_and_or_b32 v148, v148, s45, v9
    v_and_or_b32 v149, v149, s45, v9
    v_and_or_b32 v150, v150, s45, v9
    v_and_or_b32 v151, v151, s45, v9
    global_store_dwordx4 v18, v[148:151], s[40:41] sc1
    s_mov_b64 exec, -1
L_FIN:
    s_endpgm
L_ROLE_FFN:
    s_waitcnt vmcnt(2)
    global_load_dwordx4 v[72:75], v70, s[38:39] sc1
    global_load_lds_dwordx4 v32, s[42:43] offset:2048 nt
    s_waitcnt vmcnt(3)
    global_load_lds_dwordx4 v33, s[42:43] offset:3072 nt
    s_and_b32 s56, s31, 3
    s_min_u32 s32, s30, 4
    s_mul_i32 s33, s30, 3
    s_add_u32 s32, s32, s33
    s_lshl_b32 s32, s32, 2
    s_add_u32 s32, s32, s31
    s_sub_u32 s57, s32, 16
    v_lshrrev_b32 v24, 1, v0
    v_mul_u32_u24 v24, 3584, v24
    v_and_b32 v25, 1, v0
    v_lshl_add_u32 v80, v25, 4, v24
    s_add_u32 s32, s56, 0
    s_and_b32 s33, s32, 1
    s_bfe_u32 s32, s32, 0x10001
    s_lshl_b32 s34, s29, 1
    s_add_u32 s34, s34, s33
    s_lshl_b32 s35, s32, 4
    s_add_u32 s35, s35, s34
    s_lshl_b32 s35, s35, 10
    s_add_u32 s52, s35, 0x10000
    s_mul_i32 s34, s34, 114688
    s_lshl_b32 s33, s57, 5
    s_add_u32 s34, s34, s33
    s_cmp_eq_u32 s32, 0
    s_cselect_b64 s[6:7], s[16:17], s[18:19]
    s_add_u32 s6, s6, s34
    s_addc_u32 s7, s7, 0
    s_add_u32 s32, s56, 1
    s_and_b32 s33, s32, 1
    s_bfe_u32 s32, s32, 0x10001
    s_lshl_b32 s34, s29, 1
    s_add_u32 s34, s34, s33
    s_lshl_b32 s35, s32, 4
    s_add_u32 s35, s35, s34
    s_lshl_b32 s35, s35, 10
    s_add_u32 s53, s35, 0x10000
    s_mul_i32 s34, s34, 114688
    s_lshl_b32 s33, s57, 5
    s_add_u32 s34, s34, s33
    s_cmp_eq_u32 s32, 0
    s_cselect_b64 s[8:9], s[16:17], s[18:19]
    s_add_u32 s8, s8, s34
    s_addc_u32 s9, s9, 0
    s_add_u32 s32, s56, 2
    s_and_b32 s33, s32, 1
    s_bfe_u32 s32, s32, 0x10001
    s_lshl_b32 s34, s29, 1
    s_add_u32 s34, s34, s33
    s_lshl_b32 s35, s32, 4
    s_add_u32 s35, s35, s34
    s_lshl_b32 s35, s35, 10
    s_add_u32 s58, s35, 0x10000
    s_mul_i32 s34, s34, 114688
    s_lshl_b32 s33, s57, 5
    s_add_u32 s34, s34, s33
    s_cmp_eq_u32 s32, 0
    s_cselect_b64 s[10:11], s[16:17], s[18:19]
    s_add_u32 s10, s10, s34
    s_addc_u32 s11, s11, 0
    s_add_u32 s32, s56, 3
    s_and_b32 s33, s32, 1
    s_bfe_u32 s32, s32, 0x10001
    s_lshl_b32 s34, s29, 1
    s_add_u32 s34, s34, s33
    s_lshl_b32 s35, s32, 4
    s_add_u32 s35, s35, s34
    s_lshl_b32 s35, s35, 10
    s_add_u32 s59, s35, 0x10000
    s_mul_i32 s34, s34, 114688
    s_lshl_b32 s33, s57, 5
    s_add_u32 s34, s34, s33
    s_cmp_eq_u32 s32, 0
    s_cselect_b64 s[12:13], s[16:17], s[18:19]
    s_add_u32 s12, s12, s34
    s_addc_u32 s13, s13, 0
    s_lshl_b32 s32, s57, 14
    s_lshl_b32 s33, s29, 7
    s_add_u32 s32, s32, s33
    s_add_u32 s98, s20, s32
    s_addc_u32 s99, s21, 0
    s_lshl_b32 s33, s29, 11
    s_add_u32 s100, s33, 0x18000
    v_lshlrev_b32 v82, 4, v12
    v_lshl_or_b32 v82, v11, 10, v82
    v_add_u32 v83, 0x1c00, v82
    s_waitcnt vmcnt(3)
    s_mov_b32 m0, s100
    s_nop 0
    global_load_lds_dwordx4 v82, s[98:99] offset:0 nt
    s_mov_b32 m0, s100
    s_nop 0
    global_load_lds_dwordx4 v83, s[98:99] offset:1024 nt
    ds_read_b128 v[84:87], v52
    ds_read_b128 v[88:91], v53
    ds_read_b128 v[92:95], v54
    ds_read_b128 v[96:99], v55
    s_mov_b32 s49, 0
    s_branch L_CHECK8
L_RETRY8:
    s_add_u32 s49, s49, 1
    s_cmp_ge_u32 s49, 0x40000
    s_cbranch_scc1 L_OK8
    s_mov_b64 exec, vcc
    global_load_dwordx4 v[72:75], v70, s[38:39] sc1
    s_waitcnt vmcnt(0)
L_CHECK8:
    s_waitcnt vmcnt(4)
    v_xor_b32 v72, s46, v72
    v_xor_b32 v73, s46, v73
    v_xor_b32 v74, s46, v74
    v_xor_b32 v75, s46, v75
    v_or3_b32 v24, v72, v73, v74
    v_or_b32 v24, v24, v75
    v_and_b32 v24, 0xff, v24
    v_cmp_ne_u32 vcc, 0, v24
    s_cbranch_vccnz L_RETRY8
L_OK8:
    s_mov_b64 exec, -1
    v_permlane32_swap_b32 v72, v74
    v_permlane32_swap_b32 v73, v75
    v_add_f32 v72, v72, v74
    v_add_f32 v73, v73, v75
    s_nop 1
    v_permlane16_swap_b32 v72, v73
    v_add_f32 v72, v72, v73
    v_cvt_pk_bf16_f32 v72, v72, v72
    ds_write_b16 v61, v72
    s_waitcnt lgkmcnt(0)
    s_barrier
    ds_read_b128 v[100:103], v60 offset:0
    ds_read_b128 v[104:107], v60 offset:64
    ds_read_b128 v[108:111], v60 offset:128
    ds_read_b128 v[112:115], v60 offset:192
    s_waitcnt lgkmcnt(3)
    v_mfma_f32_16x16x32_bf16 v[20:23], v[84:87], v[100:103], 0
    s_waitcnt lgkmcnt(2)
    v_mfma_f32_16x16x32_bf16 v[20:23], v[88:91], v[104:107], v[20:23]
    s_waitcnt lgkmcnt(1)
    v_mfma_f32_16x16x32_bf16 v[20:23], v[92:95], v[108:111], v[20:23]
    s_waitcnt lgkmcnt(0)
    v_mfma_f32_16x16x32_bf16 v[20:23], v[96:99], v[112:115], v[20:23]
    s_nop 7
    v_cvt_pk_bf16_f32 v24, v20, v21
    v_cvt_pk_bf16_f32 v25, v22, v23
    v_lshlrev_b32 v116, 16, v24
    v_and_b32 v117, 0xffff0000, v24
    v_lshlrev_b32 v118, 16, v25
    v_and_b32 v119, 0xffff0000, v25
    v_pk_mul_f32 v[116:117], v[116:117], s[14:15] op_sel_hi:[1,0]
    v_pk_mul_f32 v[118:119], v[118:119], s[14:15] op_sel_hi:[1,0]
    v_cvt_pk_bf16_f32 v24, v116, v117
    v_cvt_pk_bf16_f32 v25, v118, v119
    v_lshlrev_b32 v116, 16, v24
    v_and_b32 v117, 0xffff0000, v24
    v_lshlrev_b32 v118, 16, v25
    v_and_b32 v119, 0xffff0000, v25
    v_max3_f32 v120, v116, v117, v118
    v_max_f32 v120, v120, v119
    v_mov_b32 v24, v120
    s_nop 1
    v_permlane16_swap_b32 v120, v24
    v_max_f32 v120, v120, v24
    v_mov_b32 v24, v120
    s_nop 1
    v_permlane32_swap_b32 v120, v24
    v_max_f32 v120, v120, v24
    s_mov_b32 exec_lo, 0xf
    s_mov_b32 exec_hi, 0x0
    ds_write_b32 v62, v120
    s_mov_b64 exec, -1
    s_mov_b32 exec_lo, 0xffffffff
    s_mov_b32 exec_hi, 0x0
    s_mov_b32 m0, s52
    s_nop 0
    global_load_lds_dwordx4 v80, s[6:7] nt
    s_mov_b64 exec, -1
    s_waitcnt lgkmcnt(0)
    s_barrier
    ds_read_b128 v[24:27], v63
    ds_read_b128 v[28:31], v63 offset:16
    s_waitcnt lgkmcnt(0)
    v_max3_f32 v24, v24, v25, v26
    v_max3_f32 v28, v28, v29, v30
    v_max3_f32 v24, v24, v27, v31
    v_max_f32 v124, v24, v28
    v_pk_add_f32 v[116:117], v[116:117], v[124:125] op_sel_hi:[1,0] neg_lo:[0,1] neg_hi:[0,1]
    v_pk_add_f32 v[118:119], v[118:119], v[124:125] op_sel_hi:[1,0] neg_lo:[0,1] neg_hi:[0,1]
    v_pk_mul_f32 v[116:117], v[116:117], s[14:15] op_sel:[0,1] op_sel_hi:[1,1]
    v_pk_mul_f32 v[118:119], v[118:119], s[14:15] op_sel:[0,1] op_sel_hi:[1,1]
    v_exp_f32 v116, v116
    v_exp_f32 v117, v117
    v_exp_f32 v118, v118
    v_exp_f32 v119, v119
    v_cvt_pk_bf16_f32 v26, v116, v117
    v_cvt_pk_bf16_f32 v27, v118, v119
    s_mov_b32 exec_lo, 0xf000f
    s_mov_b32 exec_hi, 0xf000f
    ds_write_b64 v65, v[26:27]
    v_pk_add_f32 v[24:25], v[116:117], v[118:119]
    v_add_f32 v24, v24, v25
    ds_write_b32 v64, v24
    s_mov_b64 exec, -1
    s_waitcnt lgkmcnt(0)
    s_barrier
    ds_read_b128 v[100:103], v66 offset:0
    ds_read_b128 v[104:107], v66 offset:64
    ds_read_b128 v[108:111], v66 offset:128
    ds_read_b128 v[112:115], v66 offset:192
    s_cmp_lg_u32 s29, 0
    s_cbranch_scc1 L_NOML9
    ds_read_b64 v[24:25], v69
    s_mov_b32 exec_lo, 0xf
    s_mov_b32 exec_hi, 0x0
    v_lshlrev_b32 v26, 10, v0
    global_store_byte v26, v8, s[94:95] sc1
    s_mov_b64 exec, -1
    v_mov_b32 v125, s48
    v_mov_b32 v127, s48
    s_waitcnt lgkmcnt(0)
    v_add_f32 v126, v24, v25
    s_nop 1
    v_add_f32_dpp v126, v126, v126 row_ror:4 row_mask:0xf bank_mask:0xf
    s_nop 1
    v_add_f32_dpp v126, v126, v126 row_ror:8 row_mask:0xf bank_mask:0xf
    v_mov_b32 v24, v126
    s_nop 1
    v_permlane16_swap_b32 v126, v24
    v_add_f32 v126, v126, v24
    v_mov_b32 v24, v126
    s_nop 1
    v_permlane32_swap_b32 v126, v24
    v_add_f32 v126, v126, v24
    s_mov_b32 exec_lo, 0xf
    s_mov_b32 exec_hi, 0x0
    global_store_dwordx4 v68, v[124:127], s[62:63] sc1
    s_mov_b64 exec, -1
    s_waitcnt vmcnt(5)
    s_branch L_MLD9
L_NOML9:
    s_waitcnt vmcnt(3)
L_MLD9:
    s_barrier
    ds_read_b64_tr_b16 v[84:85], v67 offset:0
    ds_read_b64_tr_b16 v[86:87], v67 offset:4096
    ds_read_b64_tr_b16 v[88:89], v67 offset:8192
    ds_read_b64_tr_b16 v[90:91], v67 offset:12288
    ds_read_b64_tr_b16 v[92:93], v67 offset:16384
    ds_read_b64_tr_b16 v[94:95], v67 offset:20480
    ds_read_b64_tr_b16 v[96:97], v67 offset:24576
    ds_read_b64_tr_b16 v[98:99], v67 offset:28672
    s_waitcnt lgkmcnt(6)
    v_mfma_f32_16x16x32_bf16 v[20:23], v[100:103], v[84:87], 0
    s_waitcnt lgkmcnt(4)
    v_mfma_f32_16x16x32_bf16 v[20:23], v[104:107], v[88:91], v[20:23]
    s_waitcnt lgkmcnt(2)
    v_mfma_f32_16x16x32_bf16 v[20:23], v[108:111], v[92:95], v[20:23]
    s_waitcnt lgkmcnt(0)
    v_mfma_f32_16x16x32_bf16 v[20:23], v[112:115], v[96:99], v[20:23]
    s_mov_b32 exec_lo, 0xffff
    s_mov_b32 exec_hi, 0x0
    s_nop 5
    v_and_or_b32 v20, v20, s45, v9
    v_and_or_b32 v21, v21, s45, v9
    v_and_or_b32 v22, v22, s45, v9
    v_and_or_b32 v23, v23, s45, v9
    global_store_dwordx4 v68, v[20:23], s[60:61] sc1
    s_mov_b64 exec, -1
    s_barrier
    s_mov_b32 exec_lo, 0x0
    s_mov_b32 exec_hi, 0xffffffff
    s_mov_b32 m0, s52
    s_nop 0
    global_load_lds_dwordx4 v80, s[6:7] nt
    s_mov_b64 exec, -1
    s_barrier
    s_mov_b32 m0, s53
    s_nop 0
    global_load_lds_dwordx4 v80, s[8:9] sc1
    s_barrier
    s_mov_b32 m0, s58
    s_nop 0
    global_load_lds_dwordx4 v80, s[10:11] sc1
    s_barrier
    s_mov_b32 m0, s59
    s_nop 0
    global_load_lds_dwordx4 v80, s[12:13] sc1
    s_lshl_b32 s33, s29, 11
    s_lshl_b32 s32, s29, 7
    s_add_u32 s36, s4, s32
    s_addc_u32 s37, s5, 0
    v_lshl_add_u32 v26, v14, 2, v13
    v_lshlrev_b32 v26, 1, v26
    global_load_ushort v84, v26, s[36:37]
    global_load_ushort v181, v26, s[22:23]
    s_add_u32 s34, s32, 0x1e000
    v_lshl_add_u32 v176, v13, 4, s34
    v_lshrrev_b32 v26, 3, v14
    v_lshl_add_u32 v26, v12, 1, v26
    v_lshlrev_b32 v26, 6, v26
    v_lshl_add_u32 v26, v13, 4, v26
    v_add_u32 v177, 0x1e000, v26
    s_lshl_b32 s34, s29, 3
    s_add_u32 s34, s34, 0x1e800
    v_mov_b32 v178, s34
    v_lshlrev_b32 v26, 3, v12
    v_add_u32 v179, 0x1e800, v26
    v_cmp_eq_u32 vcc, 0, v14
    s_nop 1
    v_cndmask_b32 v164, 0, -1, vcc
    v_cmp_eq_u32 vcc, 1, v14
    s_nop 1
    v_cndmask_b32 v165, 0, -1, vcc
    v_cmp_eq_u32 vcc, 2, v14
    s_nop 1
    v_cndmask_b32 v166, 0, -1, vcc
    v_cmp_eq_u32 vcc, 3, v14
    s_nop 1
    v_cndmask_b32 v167, 0, -1, vcc
    s_lshl_b32 s32, s29, 8
    s_add_u32 s32, s32, 0x40000
    s_add_u32 s38, s26, s32
    s_addc_u32 s39, s27, 0
    v_lshlrev_b32 v26, 4, v14
    v_mul_u32_u24 v104, 2048, v13
    v_add_u32 v104, v104, v26
    v_add_u32 v105, 0x2000, v104
    v_add_u32 v106, 0x4000, v104
    v_add_u32 v107, 0x6000, v104
    s_mul_i32 s32, s29, 28672
    s_lshl_b32 s34, s57, 6
    s_add_u32 s32, s32, s34
    s_add_u32 s32, s32, 0xf8000
    s_add_u32 s40, s26, s32
    s_addc_u32 s41, s27, 0
    v_lshrrev_b32 v26, 2, v14
    v_mul_u32_u24 v26, 7168, v26
    v_and_b32 v27, 3, v0
    v_lshl_add_u32 v180, v27, 4, v26
    v_lshrrev_b32 v26, 2, v14
    v_and_b32 v27, 3, v0
    v_lshl_add_u32 v28, v26, 2, v13
    v_lshlrev_b32 v28, 5, v28
    v_lshl_add_u32 v28, v27, 3, v28
    s_add_u32 s34, s33, 0x10000
    v_add_u32 v28, s34, v28
    v_lshl_add_u32 v29, v13, 2, v26
    v_lshlrev_b32 v29, 7, v29
    v_lshl_add_u32 v29, v27, 3, v29
    s_add_u32 s34, s33, 0x18000
    v_add_u32 v29, s34, v29
    v_mov_b32 v148, 0x3f803f80
    v_mov_b32 v149, 0x3f803f80
    v_mov_b32 v150, 0x3f803f80
    v_mov_b32 v151, 0x3f803f80
    s_cmp_lg_u32 s29, 0
    s_cbranch_scc1 L_HINT
    s_mov_b32 s92, s48
    s_mov_b32 s93, s92
    s_and_b32 s32, s57, 15
    s_lshl_b32 s32, s32, 7
    s_add_u32 s32, s32, 0x160000
    s_mov_b32 s49, 0
L_SP10:
    s_load_dwordx8 s[4:11], s[26:27], s32 glc
    s_add_u32 s49, s49, 1
    s_cmp_ge_u32 s49, 0x40000
    s_waitcnt lgkmcnt(0)
    s_cbranch_scc1 L_SPD10
    s_xor_b64 s[4:5], s[4:5], s[92:93]
    s_xor_b64 s[6:7], s[6:7], s[92:93]
    s_xor_b64 s[8:9], s[8:9], s[92:93]
    s_xor_b64 s[10:11], s[10:11], s[92:93]
    s_or_b64 s[4:5], s[4:5], s[6:7]
    s_or_b64 s[8:9], s[8:9], s[10:11]
    s_or_b64 s[4:5], s[4:5], s[8:9]
    s_cbranch_scc1 L_SP10
L_SPD10:
L_HINT:
    s_barrier
    global_load_dwordx4 v[88:91], v104, s[38:39] sc1
    global_load_dwordx4 v[92:95], v105, s[38:39] sc1
    global_load_dwordx4 v[96:99], v106, s[38:39] sc1
    global_load_dwordx4 v[100:103], v107, s[38:39] sc1
    s_waitcnt vmcnt(4)
    ds_read_b64_tr_b16 v[108:109], v28 offset:0
    ds_read_b64_tr_b16 v[110:111], v28 offset:512
    ds_read_b64_tr_b16 v[112:113], v28 offset:1024
    ds_read_b64_tr_b16 v[114:115], v28 offset:1536
    ds_read_b64_tr_b16 v[116:117], v28 offset:16384
    ds_read_b64_tr_b16 v[118:119], v28 offset:16896
    ds_read_b64_tr_b16 v[120:121], v28 offset:17408
    ds_read_b64_tr_b16 v[122:123], v28 offset:17920
    v_mov_b32 v182, v29
    ds_read_b64_tr_b16 v[124:125], v182 offset:0
    ds_read_b64_tr_b16 v[126:127], v182 offset:32
    ds_read_b64_tr_b16 v[128:129], v182 offset:64
    ds_read_b64_tr_b16 v[130:131], v182 offset:96
    v_lshlrev_b32 v84, 16, v84
    s_waitcnt lgkmcnt(0)
    v_mfma_f32_16x16x32_bf16 v[20:23], v[108:111], v[148:151], 0
    v_mfma_f32_16x16x32_bf16 v[156:159], v[116:119], v[148:151], 0
    v_mfma_f32_16x16x32_bf16 v[20:23], v[112:115], v[148:151], v[20:23]
    v_mfma_f32_16x16x32_bf16 v[156:159], v[120:123], v[148:151], v[156:159]
    s_mov_b32 exec_lo, 0x10001
    s_mov_b32 exec_hi, 0x10001
    s_nop 4
    ds_write_b128 v176, v[20:23] offset:1024
    ds_write_b128 v176, v[156:159] offset:1088
    s_mov_b64 exec, -1
    s_mov_b32 s49, 0
    s_branch L_FIRST11
L_RETRY11:
    s_add_u32 s49, s49, 1
    s_cmp_ge_u32 s49, 0x40000
    s_cbranch_scc1 L_REDO11
    s_mov_b64 exec, vcc
    global_load_dwordx4 v[88:91], v104, s[38:39] sc1
    global_load_dwordx4 v[92:95], v105, s[38:39] sc1
    global_load_dwordx4 v[96:99], v106, s[38:39] sc1
    global_load_dwordx4 v[100:103], v107, s[38:39] sc1
    s_waitcnt vmcnt(0)
    v_xor_b32 v88, s47, v88
    v_xor_b32 v89, s47, v89
    v_xor_b32 v90, s47, v90
    v_xor_b32 v91, s47, v91
    v_or3_b32 v10, v88, v89, v90
    v_or_b32 v10, v10, v91
    v_xor_b32 v92, s47, v92
    v_xor_b32 v93, s47, v93
    v_xor_b32 v94, s47, v94
    v_xor_b32 v95, s47, v95
    v_or3_b32 v10, v10, v92, v93
    v_or3_b32 v10, v10, v94, v95
    v_xor_b32 v96, s47, v96
    v_xor_b32 v97, s47, v97
    v_xor_b32 v98, s47, v98
    v_xor_b32 v99, s47, v99
    v_or3_b32 v10, v10, v96, v97
    v_or3_b32 v10, v10, v98, v99
    v_xor_b32 v100, s47, v100
    v_xor_b32 v101, s47, v101
    v_xor_b32 v102, s47, v102
    v_xor_b32 v103, s47, v103
    v_or3_b32 v10, v10, v100, v101
    v_or3_b32 v10, v10, v102, v103
    v_and_b32 v10, 0x3ff, v10
    v_cmp_ne_u32 vcc, 0, v10
    s_cbranch_vccnz L_RETRY11
L_REDO11:
    s_mov_b64 exec, -1
    v_pk_add_f32 v[184:185], v[88:89], v[92:93]
    v_pk_add_f32 v[186:187], v[90:91], v[94:95]
    v_pk_add_f32 v[184:185], v[184:185], v[96:97]
    v_pk_add_f32 v[186:187], v[186:187], v[98:99]
    v_pk_add_f32 v[184:185], v[184:185], v[100:101]
    v_pk_add_f32 v[186:187], v[186:187], v[102:103]
    s_branch L_OK11
L_FIRST11:
    s_waitcnt vmcnt(3)
    v_xor_b32 v88, s47, v88
    v_xor_b32 v89, s47, v89
    v_xor_b32 v90, s47, v90
    v_xor_b32 v91, s47, v91
    v_or3_b32 v10, v88, v89, v90
    v_or_b32 v10, v10, v91
    s_waitcnt vmcnt(2)
    v_xor_b32 v92, s47, v92
    v_xor_b32 v93, s47, v93
    v_xor_b32 v94, s47, v94
    v_xor_b32 v95, s47, v95
    v_or3_b32 v10, v10, v92, v93
    v_or3_b32 v10, v10, v94, v95
    v_pk_add_f32 v[184:185], v[88:89], v[92:93]
    v_pk_add_f32 v[186:187], v[90:91], v[94:95]
    s_waitcnt vmcnt(1)
    v_xor_b32 v96, s47, v96
    v_xor_b32 v97, s47, v97
    v_xor_b32 v98, s47, v98
    v_xor_b32 v99, s47, v99
    v_or3_b32 v10, v10, v96, v97
    v_or3_b32 v10, v10, v98, v99
    v_pk_add_f32 v[184:185], v[184:185], v[96:97]
    v_pk_add_f32 v[186:187], v[186:187], v[98:99]
    s_waitcnt vmcnt(0)
    v_xor_b32 v100, s47, v100
    v_xor_b32 v101, s47, v101
    v_xor_b32 v102, s47, v102
    v_xor_b32 v103, s47, v103
    v_or3_b32 v10, v10, v100, v101
    v_or3_b32 v10, v10, v102, v103
    v_and_b32 v10, 0x3ff, v10
    v_cmp_ne_u32 vcc, 0, v10
    v_pk_add_f32 v[184:185], v[184:185], v[100:101]
    v_pk_add_f32 v[186:187], v[186:187], v[102:103]
    s_cbranch_vccnz L_RETRY11
L_OK11:
    s_nop 0
    v_permlane32_swap_b32 v184, v186
    v_permlane32_swap_b32 v185, v187
    v_add_f32 v184, v184, v186
    v_add_f32 v185, v185, v187
    s_nop 1
    v_permlane16_swap_b32 v184, v185
    v_add_f32 v184, v184, v185
    v_cvt_pk_bf16_f32 v184, v184, v184
    v_and_b32 v184, 0xffff0000, v184
    v_add_f32 v184, v184, v84
    v_cvt_pk_bf16_f32 v181, v184, v184
    v_and_b32 v181, 0xffff0000, v181
    v_mov_b32_dpp v185, v184 quad_perm:[1,1,3,3] row_mask:0xf bank_mask:0xf
    v_cvt_pk_bf16_f32 v185, v184, v185
    v_mul_f32 v25, v181, v181
    v_add_f32_dpp v24, v181, v181 row_ror:1 row_mask:0xf bank_mask:0xf
    v_mov_b32_dpp v148, v185 row_newbcast:0 row_mask:0xf bank_mask:0xf
    v_mov_b32_dpp v149, v185 row_newbcast:2 row_mask:0xf bank_mask:0xf
    v_mov_b32_dpp v150, v185 row_newbcast:4 row_mask:0xf bank_mask:0xf
    v_mov_b32_dpp v151, v185 row_newbcast:6 row_mask:0xf bank_mask:0xf
    v_mov_b32_dpp v152, v185 row_newbcast:8 row_mask:0xf bank_mask:0xf
    v_mov_b32_dpp v153, v185 row_newbcast:10 row_mask:0xf bank_mask:0xf
    v_mov_b32_dpp v154, v185 row_newbcast:12 row_mask:0xf bank_mask:0xf
    v_mov_b32_dpp v155, v185 row_newbcast:14 row_mask:0xf bank_mask:0xf
    v_mfma_f32_16x16x32_bf16 v[20:23], v[108:111], v[148:151], 0
    v_mfma_f32_16x16x32_bf16 v[156:159], v[116:119], v[148:151], 0
    v_mfma_f32_16x16x32_bf16 v[20:23], v[112:115], v[152:155], v[20:23]
    v_mfma_f32_16x16x32_bf16 v[156:159], v[120:123], v[152:155], v[156:159]
    v_add_f32_dpp v25, v25, v25 row_ror:1 row_mask:0xf bank_mask:0xf
    v_add_f32_dpp v24, v24, v24 row_ror:2 row_mask:0xf bank_mask:0xf
    s_nop 0
    v_add_f32_dpp v25, v25, v25 row_ror:2 row_mask:0xf bank_mask:0xf
    v_add_f32_dpp v24, v24, v24 row_ror:4 row_mask:0xf bank_mask:0xf
    s_nop 0
    v_add_f32_dpp v25, v25, v25 row_ror:4 row_mask:0xf bank_mask:0xf
    v_add_f32_dpp v24, v24, v24 row_ror:8 row_mask:0xf bank_mask:0xf
    s_nop 0
    v_add_f32_dpp v25, v25, v25 row_ror:8 row_mask:0xf bank_mask:0xf
    v_add_f32_dpp v24, v24, v24 row_bcast:15 row_mask:0xa bank_mask:0xf
    s_nop 0
    v_add_f32_dpp v25, v25, v25 row_bcast:15 row_mask:0xa bank_mask:0xf
    v_add_f32_dpp v24, v24, v24 row_bcast:31 row_mask:0xc bank_mask:0xf
    s_nop 0
    v_add_f32_dpp v25, v25, v25 row_bcast:31 row_mask:0xc bank_mask:0xf
    s_mov_b32 exec_lo, 0x0
    s_mov_b32 exec_hi, 0x80000000
    ds_write_b64 v178, v[24:25]
    s_mov_b32 exec_lo, 0x10001
    s_mov_b32 exec_hi, 0x10001
    ds_write_b128 v176, v[20:23]
    ds_write_b128 v176, v[156:159] offset:64
    s_mov_b64 exec, -1
    s_waitcnt lgkmcnt(0)
    s_barrier
    ds_read_b64 v[24:25], v179
    ds_read_b128 v[20:23], v177
    ds_read_b128 v[160:163], v177 offset:1024
    s_waitcnt lgkmcnt(2)
    v_add_f32_dpp v24, v24, v24 quad_perm:[1,0,3,2] row_mask:0xf bank_mask:0xf
    v_add_f32_dpp v25, v25, v25 quad_perm:[1,0,3,2] row_mask:0xf bank_mask:0xf
    s_nop 0
    v_add_f32_dpp v24, v24, v24 quad_perm:[2,3,0,1] row_mask:0xf bank_mask:0xf
    v_add_f32_dpp v25, v25, v25 quad_perm:[2,3,0,1] row_mask:0xf bank_mask:0xf
    s_nop 0
    v_add_f32_dpp v24, v24, v24 row_half_mirror row_mask:0xf bank_mask:0xf
    v_add_f32_dpp v25, v25, v25 row_half_mirror row_mask:0xf bank_mask:0xf
    s_waitcnt lgkmcnt(0)
    v_mul_f32 v24, 0x3b000000, v24
    v_cvt_pk_bf16_f32 v26, v24, v24
    v_and_b32 v26, 0xffff0000, v26
    v_pk_fma_f32 v[20:21], v[26:27], v[160:161], v[20:21] op_sel_hi:[0,1,1] neg_lo:[1,0,0] neg_hi:[1,0,0]
    v_pk_fma_f32 v[22:23], v[26:27], v[162:163], v[22:23] op_sel_hi:[0,1,1] neg_lo:[1,0,0] neg_hi:[1,0,0]
    s_nop 0
    v_add_f32_dpp v20, v20, v20 quad_perm:[1,0,3,2] row_mask:0xf bank_mask:0xf
    v_add_f32_dpp v21, v21, v21 quad_perm:[1,0,3,2] row_mask:0xf bank_mask:0xf
    v_add_f32_dpp v22, v22, v22 quad_perm:[1,0,3,2] row_mask:0xf bank_mask:0xf
    v_add_f32_dpp v23, v23, v23 quad_perm:[1,0,3,2] row_mask:0xf bank_mask:0xf
    v_add_f32_dpp v20, v20, v20 quad_perm:[2,3,0,1] row_mask:0xf bank_mask:0xf
    v_add_f32_dpp v21, v21, v21 quad_perm:[2,3,0,1] row_mask:0xf bank_mask:0xf
    v_add_f32_dpp v22, v22, v22 quad_perm:[2,3,0,1] row_mask:0xf bank_mask:0xf
    v_add_f32_dpp v23, v23, v23 quad_perm:[2,3,0,1] row_mask:0xf bank_mask:0xf
    v_add_f32_dpp v20, v20, v20 row_half_mirror row_mask:0xf bank_mask:0xf
    v_add_f32_dpp v21, v21, v21 row_half_mirror row_mask:0xf bank_mask:0xf
    v_add_f32_dpp v22, v22, v22 row_half_mirror row_mask:0xf bank_mask:0xf
    v_add_f32_dpp v23, v23, v23 row_half_mirror row_mask:0xf bank_mask:0xf
    v_mul_f32 v25, 0x3b000000, v25
    v_fma_f32 v25, -v24, v24, v25
    v_mul_f32_dpp v28, v20, v20 row_ror:8 row_mask:0xf bank_mask:0xf
    v_mul_f32_dpp v29, v21, v21 row_ror:8 row_mask:0xf bank_mask:0xf
    v_mul_f32_dpp v30, v22, v22 row_ror:8 row_mask:0xf bank_mask:0xf
    v_mul_f32_dpp v31, v23, v23 row_ror:8 row_mask:0xf bank_mask:0xf
    v_cvt_pk_bf16_f32 v26, v28, v29
    v_cvt_pk_bf16_f32 v27, v30, v31
    v_and_b32 v168, v26, v164
    v_and_b32 v169, v27, v164
    v_and_b32 v170, v26, v165
    v_and_b32 v171, v27, v165
    v_mfma_f32_16x16x16_bf16 v[156:159], v[168:169], v[124:125], 0
    v_and_b32 v172, v26, v166
    v_and_b32 v173, v27, v166
    v_mfma_f32_16x16x16_bf16 v[156:159], v[170:171], v[126:127], v[156:159]
    v_and_b32 v174, v26, v167
    v_and_b32 v175, v27, v167
    v_mfma_f32_16x16x16_bf16 v[156:159], v[172:173], v[128:129], v[156:159]
    v_max_f32 v25, 0, v25
    v_mfma_f32_16x16x16_bf16 v[156:159], v[174:175], v[130:131], v[156:159]
    v_cvt_pk_bf16_f32 v25, v25, v25
    v_and_b32 v25, 0xffff0000, v25
    v_add_f32 v25, 0x3727c5ac, v25
    v_cvt_pk_bf16_f32 v25, v25, v25
    v_and_b32 v25, 0xffff0000, v25
    v_sqrt_f32 v25, v25
    s_nop 0
    v_cvt_pk_bf16_f32 v25, v25, v25
    v_and_b32 v25, 0xffff0000, v25
    v_mul_f32 v25, v25, v25
    v_rcp_f32 v24, v25
    s_mov_b32 exec_lo, 0xffff
    s_mov_b32 exec_hi, 0x0
    v_pk_mul_f32 v[156:157], v[156:157], v[24:25] op_sel_hi:[1,0]
    v_pk_mul_f32 v[158:159], v[158:159], v[24:25] op_sel_hi:[1,0]
    v_and_or_b32 v156, v156, s45, v9
    v_and_or_b32 v157, v157, s45, v9
    v_and_or_b32 v158, v158, s45, v9
    v_and_or_b32 v159, v159, s45, v9
    global_store_dwordx4 v180, v[156:159], s[40:41] sc1
    s_lshr_b32 s32, s57, 2
    s_cmp_lg_u32 s32, s29
    s_cbranch_scc1 L_FIN2
    s_mov_b64 exec, -1
    v_and_b32 v24, 3, v0
    v_lshlrev_b32 v25, 2, v13
    v_lshl_add_u32 v25, v24, 4, v25
    v_add_u32 v25, s56, v25
    v_lshlrev_b32 v25, 2, v25
    ds_bpermute_b32 v181, v25, v181
    v_lshl_add_u32 v216, v13, 4, v24
    v_lshlrev_b32 v216, 1, v216
    s_lshl_b32 s32, s29, 7
    s_lshl_b32 s33, s56, 3
    s_add_u32 s32, s32, s33
    s_add_u32 s42, s22, s32
    s_addc_u32 s43, s23, 0
    s_mul_i32 s33, s57, 7168
    s_add_u32 s33, s33, 0xf8c00
    s_add_u32 s40, s26, s33
    s_addc_u32 s41, s27, 0
    s_waitcnt vmcnt(0)
    global_load_dwordx4 v[188:191], v68, s[40:41] offset:-3072 sc1
    global_load_dwordx4 v[192:195], v68, s[40:41] offset:-2048 sc1
    global_load_dwordx4 v[196:199], v68, s[40:41] offset:-1024 sc1
    global_load_dwordx4 v[200:203], v68, s[40:41] offset:0 sc1
    global_load_dwordx4 v[204:207], v68, s[40:41] offset:1024 sc1
    global_load_dwordx4 v[208:211], v68, s[40:41] offset:2048 sc1
    global_load_dwordx4 v[212:215], v68, s[40:41] offset:3072 sc1
    s_mov_b32 s49, 0
    s_branch L_FIRST12
L_RETRY12:
    s_add_u32 s49, s49, 1
    s_cmp_ge_u32 s49, 0x40000
    s_cbranch_scc1 L_REDO12
    s_mov_b64 exec, vcc
    global_load_dwordx4 v[188:191], v68, s[40:41] offset:-3072 sc1
    global_load_dwordx4 v[192:195], v68, s[40:41] offset:-2048 sc1
    global_load_dwordx4 v[196:199], v68, s[40:41] offset:-1024 sc1
    global_load_dwordx4 v[200:203], v68, s[40:41] offset:0 sc1
    global_load_dwordx4 v[204:207], v68, s[40:41] offset:1024 sc1
    global_load_dwordx4 v[208:211], v68, s[40:41] offset:2048 sc1
    global_load_dwordx4 v[212:215], v68, s[40:41] offset:3072 sc1
    s_waitcnt vmcnt(0)
    v_xor_b32 v188, s47, v188
    v_xor_b32 v189, s47, v189
    v_xor_b32 v190, s47, v190
    v_xor_b32 v191, s47, v191
    v_or3_b32 v10, v188, v189, v190
    v_or_b32 v10, v10, v191
    v_xor_b32 v192, s47, v192
    v_xor_b32 v193, s47, v193
    v_xor_b32 v194, s47, v194
    v_xor_b32 v195, s47, v195
    v_or3_b32 v10, v10, v192, v193
    v_or3_b32 v10, v10, v194, v195
    v_xor_b32 v196, s47, v196
    v_xor_b32 v197, s47, v197
    v_xor_b32 v198, s47, v198
    v_xor_b32 v199, s47, v199
    v_or3_b32 v10, v10, v196, v197
    v_or3_b32 v10, v10, v198, v199
    v_xor_b32 v200, s47, v200
    v_xor_b32 v201, s47, v201
    v_xor_b32 v202, s47, v202
    v_xor_b32 v203, s47, v203
    v_or3_b32 v10, v10, v200, v201
    v_or3_b32 v10, v10, v202, v203
    v_xor_b32 v204, s47, v204
    v_xor_b32 v205, s47, v205
    v_xor_b32 v206, s47, v206
    v_xor_b32 v207, s47, v207
    v_or3_b32 v10, v10, v204, v205
    v_or3_b32 v10, v10, v206, v207
    v_xor_b32 v208, s47, v208
    v_xor_b32 v209, s47, v209
    v_xor_b32 v210, s47, v210
    v_xor_b32 v211, s47, v211
    v_or3_b32 v10, v10, v208, v209
    v_or3_b32 v10, v10, v210, v211
    v_xor_b32 v212, s47, v212
    v_xor_b32 v213, s47, v213
    v_xor_b32 v214, s47, v214
    v_xor_b32 v215, s47, v215
    v_or3_b32 v10, v10, v212, v213
    v_or3_b32 v10, v10, v214, v215
    v_and_b32 v10, 0x3ff, v10
    v_cmp_ne_u32 vcc, 0, v10
    s_cbranch_vccnz L_RETRY12
L_REDO12:
    s_mov_b64 exec, -1
    v_pk_add_f32 v[184:185], v[188:189], v[192:193]
    v_pk_add_f32 v[186:187], v[190:191], v[194:195]
    v_pk_add_f32 v[184:185], v[184:185], v[196:197]
    v_pk_add_f32 v[186:187], v[186:187], v[198:199]
    v_pk_add_f32 v[184:185], v[184:185], v[200:201]
    v_pk_add_f32 v[186:187], v[186:187], v[202:203]
    v_pk_add_f32 v[184:185], v[184:185], v[204:205]
    v_pk_add_f32 v[186:187], v[186:187], v[206:207]
    v_pk_add_f32 v[184:185], v[184:185], v[208:209]
    v_pk_add_f32 v[186:187], v[186:187], v[210:211]
    v_pk_add_f32 v[184:185], v[184:185], v[212:213]
    v_pk_add_f32 v[186:187], v[186:187], v[214:215]
    s_branch L_OK12
L_FIRST12:
    s_waitcnt vmcnt(6)
    v_xor_b32 v188, s47, v188
    v_xor_b32 v189, s47, v189
    v_xor_b32 v190, s47, v190
    v_xor_b32 v191, s47, v191
    v_or3_b32 v10, v188, v189, v190
    v_or_b32 v10, v10, v191
    s_waitcnt vmcnt(5)
    v_xor_b32 v192, s47, v192
    v_xor_b32 v193, s47, v193
    v_xor_b32 v194, s47, v194
    v_xor_b32 v195, s47, v195
    v_or3_b32 v10, v10, v192, v193
    v_or3_b32 v10, v10, v194, v195
    v_pk_add_f32 v[184:185], v[188:189], v[192:193]
    v_pk_add_f32 v[186:187], v[190:191], v[194:195]
    s_waitcnt vmcnt(4)
    v_xor_b32 v196, s47, v196
    v_xor_b32 v197, s47, v197
    v_xor_b32 v198, s47, v198
    v_xor_b32 v199, s47, v199
    v_or3_b32 v10, v10, v196, v197
    v_or3_b32 v10, v10, v198, v199
    v_pk_add_f32 v[184:185], v[184:185], v[196:197]
    v_pk_add_f32 v[186:187], v[186:187], v[198:199]
    s_waitcnt vmcnt(3)
    v_xor_b32 v200, s47, v200
    v_xor_b32 v201, s47, v201
    v_xor_b32 v202, s47, v202
    v_xor_b32 v203, s47, v203
    v_or3_b32 v10, v10, v200, v201
    v_or3_b32 v10, v10, v202, v203
    v_pk_add_f32 v[184:185], v[184:185], v[200:201]
    v_pk_add_f32 v[186:187], v[186:187], v[202:203]
    s_waitcnt vmcnt(2)
    v_xor_b32 v204, s47, v204
    v_xor_b32 v205, s47, v205
    v_xor_b32 v206, s47, v206
    v_xor_b32 v207, s47, v207
    v_or3_b32 v10, v10, v204, v205
    v_or3_b32 v10, v10, v206, v207
    v_pk_add_f32 v[184:185], v[184:185], v[204:205]
    v_pk_add_f32 v[186:187], v[186:187], v[206:207]
    s_waitcnt vmcnt(1)
    v_xor_b32 v208, s47, v208
    v_xor_b32 v209, s47, v209
    v_xor_b32 v210, s47, v210
    v_xor_b32 v211, s47, v211
    v_or3_b32 v10, v10, v208, v209
    v_or3_b32 v10, v10, v210, v211
    v_pk_add_f32 v[184:185], v[184:185], v[208:209]
    v_pk_add_f32 v[186:187], v[186:187], v[210:211]
    s_waitcnt vmcnt(0)
    v_xor_b32 v212, s47, v212
    v_xor_b32 v213, s47, v213
    v_xor_b32 v214, s47, v214
    v_xor_b32 v215, s47, v215
    v_or3_b32 v10, v10, v212, v213
    v_or3_b32 v10, v10, v214, v215
    v_and_b32 v10, 0x3ff, v10
    v_cmp_ne_u32 vcc, 0, v10
    v_pk_add_f32 v[184:185], v[184:185], v[212:213]
    v_pk_add_f32 v[186:187], v[186:187], v[214:215]
    s_cbranch_vccnz L_RETRY12
L_OK12:
    s_nop 0
    v_permlane32_swap_b32 v184, v186
    v_permlane32_swap_b32 v185, v187
    v_add_f32 v184, v184, v186
    v_add_f32 v185, v185, v187
    s_nop 1
    v_permlane16_swap_b32 v184, v185
    v_add_f32 v184, v184, v185
    s_nop 1
    v_add_f32_dpp v184, v184, v184 row_ror:4 row_mask:0xf bank_mask:0xf
    s_nop 1
    v_add_f32_dpp v184, v184, v184 row_ror:8 row_mask:0xf bank_mask:0xf
    v_cvt_pk_bf16_f32 v184, v184, v184
    v_and_b32 v184, 0xffff0000, v184
    s_waitcnt lgkmcnt(0)
    v_add_f32 v184, v184, v181
    v_cvt_pk_bf16_f32 v184, v184, v184
    s_mov_b32 exec_lo, 0xf000f
    s_mov_b32 exec_hi, 0xf000f
    global_store_short v216, v184, s[42:43] sc1
    s_cmp_lg_u32 s57, 0
    s_cbranch_scc1 L_FIN2
    s_mov_b32 exec_lo, 0x1
    s_mov_b32 exec_hi, 0x0
    v_mov_b32 v24, 0
    v_mov_b32 v25, s48
    global_store_dword v24, v25, s[26:27] sc1
L_FIN2:
    s_endpgm
L_END:
    s_endpgm
L_CODE_END:
.section .rodata,"a"
.p2align 6
.amdhsa_kernel sequential_preLN__sliding_block_cached__glu_gated_bilinear__decode_kernel
  .amdhsa_next_free_vgpr 224
  .amdhsa_next_free_sgpr 102
  .amdhsa_accum_offset 224
  .amdhsa_group_segment_fixed_size 0
  .amdhsa_kernarg_size 96
  .amdhsa_user_sgpr_count 2
  .amdhsa_user_sgpr_kernarg_segment_ptr 1
  .amdhsa_system_sgpr_workgroup_id_x 1
  .amdhsa_float_denorm_mode_32 3
.end_amdhsa_kernel
```
